```python
import torch

def _softmax(x, axis=-1):
    return torch.softmax(x, dim=axis)
def _gelu(x):
    return torch.nn.functional.gelu(x, approximate="tanh")
def _silu(x):
    return torch.nn.functional.silu(x)
def _sigmoid(x):
    return torch.sigmoid(x)
def _layernorm(x, axis=-1, eps=1e-5):
    m = x.mean(dim=axis, keepdim=True)
    v = x.var(dim=axis, keepdim=True, unbiased=False)
    return (x - m) / torch.sqrt(v + eps)
def _scatter_add(tgt, idx, src, axis=0):
    return tgt.clone().index_add_(axis, idx, src)
def _segment_sum(src, seg, n):
    out = torch.zeros((n,) + src.shape[1:], dtype=src.dtype)
    return out.index_add_(0, seg, src)
def _pad(x, pw):
    flat = tuple(v for pair in reversed(pw) for v in pair)
    return torch.nn.functional.pad(x, flat)

kernel_name = 'standalone__weight_only_int_omniquant__prompt'

def setup_inputs():

    _w = (lambda a: (lambda t: t.to(torch.bfloat16) if t.is_floating_point() else t)(torch.as_tensor(a)))
    B, S, D, F = 1, 2048, 576, 4608
    bits = 8
    G = -1 if -1 > 0 else D
    D = (D // G) * G
    ng = D // G
    qmax = (1 << bits) - 1
    qw = torch.randint(0, qmax + 1, (D, F)).to(torch.int32)
    scales = (torch.abs((lambda *s: torch.randn(*s, dtype=torch.bfloat16) * 0.05)(ng, F)) * 0.05 + 0.01).to(float)
    zeros = torch.randint(0, qmax + 1, (ng, F)).to(float)
    act_scale = (torch.abs((lambda *s: torch.randn(*s, dtype=torch.bfloat16) * 0.05)(D)) * 0.5 + 0.5).to(float)
    return {
        "x": _w((lambda *s: torch.randn(*s, dtype=torch.bfloat16) * 0.05)(B, S, D)),
        "qw": _w(qw),
        "scales": _w(scales),
        "zeros": _w(zeros),
        "act_scale": _w(act_scale),
    }

def reference(x, qw, scales, zeros, act_scale):
    B, S, D = x.shape
    ng, F = scales.shape
    G = D // ng
    s = (lambda x, n, axis: torch.repeat_interleave(x, n, dim=axis))(scales, G, axis=0)
    z = (lambda x, n, axis: torch.repeat_interleave(x, n, dim=axis))(zeros, G, axis=0)
    w = ((lambda x, dt: x.to(dt))(qw, x.dtype) - z) * s
    xs = x * (lambda x, dt: x.to(dt))(act_scale, x.dtype)
    return torch.einsum("bsd,df->bsf", xs, w)
```

```asm
; @launch grid=(256,1,1) block=(512,1,1) lds=163840
.amdgcn_target "amdgcn-amd-amdhsa--gfx950"
.text
.globl standalone__weight_only_int_omniquant__prompt_kernel
.p2align 12
.p2align 8
.type standalone__weight_only_int_omniquant__prompt_kernel,@function
standalone__weight_only_int_omniquant__prompt_kernel:
    s_load_dwordx4 s[4:7], s[0:1], 0
    s_load_dwordx4 s[8:11], s[0:1], 16
    s_load_dwordx4 s[12:15], s[0:1], 32
    s_and_b32 s40, s2, 7
    s_lshr_b32 s41, s2, 3
    s_mul_i32 s42, s40, 63
    s_lshr_b32 s43, s42, 1
    s_add_u32 s42, s42, 63
    s_lshr_b32 s42, s42, 1
    s_add_u32 s43, s43, s41
    s_cmp_ge_u32 s43, s42
    s_cbranch_scc1 L_end
    s_mul_i32 s44, s43, 9363
    s_lshr_b32 s44, s44, 16
    s_mul_i32 s50, s44, 7
    s_sub_u32 s45, s43, s50
    v_lshrrev_b32 v1, 6, v0
    v_and_b32 v0, 63, v0
    s_sub_u32 s49, s43, s41
    s_max_u32 s49, s49, s50
    s_add_u32 s51, s50, 7
    s_min_u32 s51, s51, s42
    s_sub_u32 s51, s51, s49
    s_sub_u32 s89, s43, s49
    s_mul_i32 s89, s89, 9
    s_movk_i32 s52, 16384
    s_cmp_eq_u32 s51, 7
    s_cselect_b32 s52, 9363, s52
    s_cmp_eq_u32 s51, 3
    s_cselect_b32 s52, 21846, s52
    s_mul_i32 s89, s89, s52
    s_lshr_b32 s89, s89, 16
    s_mul_i32 s52, s40, 1
    s_add_u32 s89, s89, s52
    s_mul_i32 s49, s89, 7282
    s_lshr_b32 s49, s49, 16
    s_mul_i32 s49, s49, 9
    s_sub_u32 s89, s89, s49
    v_readfirstlane_b32 s3, v1
    s_lshl_b32 s80, s89, 7
    s_mul_i32 s46, s45, 336384
    s_lshl_b32 s47, s44, 9
    s_mul_i32 s48, s45, 2691072
    s_lshl_b32 s49, s44, 8
    s_add_u32 s48, s48, s49
    s_cmp_ge_u32 s3, 4
    s_cbranch_scc0 L_compute
    s_sub_u32 s3, s3, 4
    v_and_b32 v10, 31, v0
    v_lshrrev_b32 v11, 5, v0
    s_lshl_b32 s50, s3, 1
    v_add_u32 v12, s50, v11
    s_mov_b32 s51, 147456
    v_mul_lo_u32 v168, v12, s51
    v_lshl_add_u32 v168, v10, 4, v168
    v_add_u32 v169, 18432, v168
    v_add_u32 v170, 36864, v168
    v_add_u32 v171, 55296, v168
    v_add_u32 v172, 73728, v168
    v_add_u32 v173, 92160, v168
    v_add_u32 v174, 110592, v168
    v_add_u32 v175, 129024, v168
    v_lshlrev_b32 v5, 3, v10
    v_add_u32 v5, s49, v5
    v_lshrrev_b32 v13, 1, v0
    v_and_b32 v14, 1, v0
    v_add_u32 v13, s89, v13
    v_subrev_u32 v15, 9, v13
    v_min_u32 v13, v13, v15
    v_lshlrev_b32 v4, 7, v13
    v_lshl_add_u32 v4, v14, 4, v4
    s_lshl_b32 s50, s3, 5
    v_add_u32 v4, s50, v4
    s_waitcnt lgkmcnt(0)
    s_add_u32 s20, s6, s47
    s_addc_u32 s21, s7, 0
    s_and_b32 s21, s21, 0xffff
    s_sub_u32 s22, 10616832, s47
    s_mov_b32 s23, 0x20000
    s_mul_i32 s54, s80, 9216
    buffer_load_dwordx4 v[32:35], v168, s[20:23], s54 offen
    s_mov_b32 s24, s8
    s_and_b32 s25, s9, 0xffff
    s_mov_b32 s26, 9216
    s_mov_b32 s27, 0x20000
    s_mov_b32 s28, s10
    s_and_b32 s29, s11, 0xffff
    s_mov_b32 s30, 9216
    s_mov_b32 s31, 0x20000
    s_mov_b32 s32, s12
    s_and_b32 s33, s13, 0xffff
    s_mov_b32 s34, 1152
    s_mov_b32 s35, 0x20000
    buffer_load_dwordx2 v[16:17], v5, s[24:27], 0 offen
    buffer_load_dwordx2 v[18:19], v5, s[28:31], 0 offen
    buffer_load_dwordx4 v[24:27], v4, s[32:35], 0 offen
    buffer_load_dwordx4 v[36:39], v169, s[20:23], s54 offen
    buffer_load_dwordx4 v[40:43], v170, s[20:23], s54 offen
    buffer_load_dwordx4 v[44:47], v171, s[20:23], s54 offen
    buffer_load_dwordx4 v[48:51], v172, s[20:23], s54 offen
    buffer_load_dwordx4 v[52:55], v173, s[20:23], s54 offen
    buffer_load_dwordx4 v[56:59], v174, s[20:23], s54 offen
    buffer_load_dwordx4 v[60:63], v175, s[20:23], s54 offen
    s_add_u32 s81, s80, 128
    s_cmp_eq_u32 s81, 1152
    s_cselect_b32 s81, 0, s81
    s_add_u32 s82, s81, 128
    s_cmp_eq_u32 s82, 1152
    s_cselect_b32 s82, 0, s82
    s_add_u32 s83, s82, 128
    s_cmp_eq_u32 s83, 1152
    s_cselect_b32 s83, 0, s83
    s_add_u32 s84, s83, 128
    s_cmp_eq_u32 s84, 1152
    s_cselect_b32 s84, 0, s84
    s_add_u32 s85, s84, 128
    s_cmp_eq_u32 s85, 1152
    s_cselect_b32 s85, 0, s85
    s_add_u32 s86, s85, 128
    s_cmp_eq_u32 s86, 1152
    s_cselect_b32 s86, 0, s86
    s_add_u32 s87, s86, 128
    s_cmp_eq_u32 s87, 1152
    s_cselect_b32 s87, 0, s87
    s_add_u32 s88, s87, 128
    s_cmp_eq_u32 s88, 1152
    s_cselect_b32 s88, 0, s88
    s_mul_i32 s54, s81, 9216
    buffer_load_dwordx4 v[64:67], v168, s[20:23], s54 offen
    buffer_load_dwordx4 v[68:71], v169, s[20:23], s54 offen
    buffer_load_dwordx4 v[72:75], v170, s[20:23], s54 offen
    buffer_load_dwordx4 v[76:79], v171, s[20:23], s54 offen
    s_setreg_imm32_b32 hwreg(HW_REG_MODE, 4, 2), 3
    s_add_u32 s16, s4, s46
    s_addc_u32 s17, s5, 0
    s_and_b32 s17, s17, 0xffff
    s_sub_u32 s18, 2359296, s46
    s_mov_b32 s19, 0x20000
    s_add_u32 s36, s14, s48
    s_addc_u32 s37, s15, 0
    s_and_b32 s37, s37, 0xffff
    s_sub_u32 s38, 18874368, s48
    s_mov_b32 s39, 0x20000
    v_lshrrev_b32 v13, 3, v0
    s_and_b32 s50, s3, 1
    s_lshl_b32 s55, s50, 10
    s_lshl_b32 s50, s50, 2
    v_lshrrev_b32 v14, 1, v13
    v_add_u32 v14, s50, v14
    v_and_b32 v15, 7, v0
    v_xor_b32 v14, v14, v15
    s_lshl_b32 s50, s3, 3
    v_add_u32 v13, s50, v13
    v_mul_u32_u24 v3, 1152, v13
    v_lshl_add_u32 v3, v14, 4, v3
    s_lshl_b32 s53, s3, 10
    s_lshr_b32 s50, s3, 1
    s_mul_i32 s50, s50, 18432
    s_add_u32 s55, s55, s50
    s_sub_u32 s95, 0, s50
    v_lshrrev_b32 v13, 3, v10
    v_lshlrev_b32 v13, 12, v13
    v_and_b32 v14, 1, v10
    v_lshl_add_u32 v13, v14, 10, v13
    v_and_b32 v15, 6, v10
    v_add_u32 v15, v15, v14
    s_and_b32 s50, s3, 1
    s_lshl_b32 s50, s50, 1
    v_add_u32 v20, s50, v11
    v_lshl_add_u32 v15, v20, 4, v15
    v_lshl_add_u32 v13, v15, 4, v13
    s_lshr_b32 s50, s3, 1
    s_lshl_b32 s50, s50, 11
    v_add_u32 v6, s50, v13
    v_xor_b32 v7, 16, v6
    v_lshrrev_b32 v13, 4, v0
    s_lshl_b32 s50, s3, 2
    v_add_u32 v13, s50, v13
    v_and_b32 v14, 15, v0
    v_and_b32 v15, 7, v13
    v_xor_b32 v15, v15, v14
    v_lshlrev_b32 v8, 8, v13
    v_lshl_add_u32 v8, v15, 4, v8
    v_mul_u32_u24 v9, 9216, v13
    v_lshl_add_u32 v9, v14, 4, v9
    s_add_u32 s50, s53, 32768
    v_min_u32 v22, 31, v0
    v_lshlrev_b32 v22, 5, v22
    v_add_u32 v22, s50, v22
    v_lshlrev_b32 v21, 5, v11
    v_add_u32 v21, s50, v21
    s_getpc_b64 s[90:91]
L_pc:
    s_sub_u32 s90, s90, L_pc-standalone__weight_only_int_omniquant__prompt_kernel
    s_subb_u32 s91, s91, 0
    s_lshl_b32 s52, s41, 2
    s_add_u32 s52, s52, s3
    s_mul_i32 s52, s52, CPL*64
    v_min_u32 v30, CPL-1, v0
    v_lshlrev_b32 v30, 6, v30
    v_add_u32 v30, s52, v30
    v_min_u32 v30, L_end-standalone__weight_only_int_omniquant__prompt_kernel, v30
    s_mov_b64 exec, 15
    global_load_dword v31, v30, s[90:91]
    s_mov_b64 exec, -1
    s_waitcnt vmcnt(12)
    v_lshlrev_b32 v128, 16, v24
    v_and_b32 v129, 0xffff0000, v24
    v_lshlrev_b32 v130, 16, v25
    v_and_b32 v131, 0xffff0000, v25
    v_lshlrev_b32 v132, 16, v26
    v_and_b32 v133, 0xffff0000, v26
    v_lshlrev_b32 v134, 16, v27
    v_and_b32 v135, 0xffff0000, v27
    s_mov_b32 s50, 0x58000000
    v_mul_f32 v128, s50, v128
    v_mul_f32 v129, s50, v129
    v_mul_f32 v130, s50, v130
    v_mul_f32 v131, s50, v131
    v_mul_f32 v132, s50, v132
    v_mul_f32 v133, s50, v133
    v_mul_f32 v134, s50, v134
    v_mul_f32 v135, s50, v135
    ds_write_b128 v22, v[128:131]
    ds_write_b128 v22, v[132:135] offset:16
    v_lshlrev_b32 v144, 16, v16
    v_and_b32 v145, 0xffff0000, v16
    v_lshlrev_b32 v148, 16, v18
    v_and_b32 v149, 0xffff0000, v18
    v_lshlrev_b32 v146, 16, v17
    v_and_b32 v147, 0xffff0000, v17
    v_lshlrev_b32 v150, 16, v19
    v_and_b32 v151, 0xffff0000, v19
    s_mov_b32 s50, 0xa7000000
    s_mov_b32 s51, 0x71800000
    v_mul_f32 v148, v148, v144
    v_mul_f32 v148, s50, v148
    v_mul_f32 v144, s51, v144
    v_mul_f32 v149, v149, v145
    v_mul_f32 v149, s50, v149
    v_mul_f32 v145, s51, v145
    v_mul_f32 v150, v150, v146
    v_mul_f32 v150, s50, v150
    v_mul_f32 v146, s51, v146
    v_mul_f32 v151, v151, v147
    v_mul_f32 v151, s50, v151
    v_mul_f32 v147, s51, v147
    s_waitcnt lgkmcnt(0)
    ds_read_b128 v[128:131], v21 offset:0
    ds_read_b128 v[132:135], v21 offset:16
    s_waitcnt vmcnt(5)
    s_waitcnt lgkmcnt(0)
    ds_read_b128 v[136:139], v21 offset:64
    ds_read_b128 v[140:143], v21 offset:80
    .p2align 3
    v_fma_f32 v32, v32, v144, v148
    v_fma_f32 v36, v36, v144, v148
    v_fma_f32 v40, v40, v144, v148
    v_fma_f32 v44, v44, v144, v148
    v_mul_f32 v32, v32, v128
    v_mul_f32 v36, v36, v129
    v_mul_f32 v40, v40, v130
    v_mul_f32 v44, v44, v131
    v_cvt_pk_bf16_f32 v152, v32, v36
    v_cvt_pk_bf16_f32 v153, v40, v44
    buffer_load_dwordx4 v[80:83], v172, s[20:23], s54 offen
    .p2align 3
    v_fma_f32 v48, v48, v144, v148
    v_fma_f32 v52, v52, v144, v148
    v_fma_f32 v56, v56, v144, v148
    v_fma_f32 v60, v60, v144, v148
    v_mul_f32 v48, v48, v132
    v_mul_f32 v52, v52, v133
    v_mul_f32 v56, v56, v134
    v_mul_f32 v60, v60, v135
    v_cvt_pk_bf16_f32 v154, v48, v52
    v_cvt_pk_bf16_f32 v155, v56, v60
    ds_write_b128 v6, v[152:155] offset:0
    buffer_load_dwordx4 v[84:87], v173, s[20:23], s54 offen
    .p2align 3
    v_fma_f32 v33, v33, v145, v149
    v_fma_f32 v37, v37, v145, v149
    v_fma_f32 v41, v41, v145, v149
    v_fma_f32 v45, v45, v145, v149
    v_mul_f32 v33, v33, v128
    v_mul_f32 v37, v37, v129
    v_mul_f32 v41, v41, v130
    v_mul_f32 v45, v45, v131
    v_cvt_pk_bf16_f32 v156, v33, v37
    v_cvt_pk_bf16_f32 v157, v41, v45
    .p2align 3
    v_fma_f32 v49, v49, v145, v149
    v_fma_f32 v53, v53, v145, v149
    v_fma_f32 v57, v57, v145, v149
    v_fma_f32 v61, v61, v145, v149
    v_mul_f32 v49, v49, v132
    v_mul_f32 v53, v53, v133
    v_mul_f32 v57, v57, v134
    v_mul_f32 v61, v61, v135
    v_cvt_pk_bf16_f32 v158, v49, v53
    v_cvt_pk_bf16_f32 v159, v57, v61
    ds_write_b128 v7, v[156:159] offset:0
    buffer_load_dwordx4 v[88:91], v174, s[20:23], s54 offen
    .p2align 3
    v_fma_f32 v34, v34, v146, v150
    v_fma_f32 v38, v38, v146, v150
    v_fma_f32 v42, v42, v146, v150
    v_fma_f32 v46, v46, v146, v150
    v_mul_f32 v34, v34, v128
    v_mul_f32 v38, v38, v129
    v_mul_f32 v42, v42, v130
    v_mul_f32 v46, v46, v131
    v_cvt_pk_bf16_f32 v160, v34, v38
    v_cvt_pk_bf16_f32 v161, v42, v46
    .p2align 3
    v_fma_f32 v50, v50, v146, v150
    v_fma_f32 v54, v54, v146, v150
    v_fma_f32 v58, v58, v146, v150
    v_fma_f32 v62, v62, v146, v150
    v_mul_f32 v50, v50, v132
    v_mul_f32 v54, v54, v133
    v_mul_f32 v58, v58, v134
    v_mul_f32 v62, v62, v135
    v_cvt_pk_bf16_f32 v162, v50, v54
    v_cvt_pk_bf16_f32 v163, v58, v62
    ds_write_b128 v6, v[160:163] offset:128
    buffer_load_dwordx4 v[92:95], v175, s[20:23], s54 offen
    .p2align 3
    v_fma_f32 v35, v35, v147, v151
    v_fma_f32 v39, v39, v147, v151
    v_fma_f32 v43, v43, v147, v151
    v_fma_f32 v47, v47, v147, v151
    v_mul_f32 v35, v35, v128
    v_mul_f32 v39, v39, v129
    v_mul_f32 v43, v43, v130
    v_mul_f32 v47, v47, v131
    v_cvt_pk_bf16_f32 v164, v35, v39
    v_cvt_pk_bf16_f32 v165, v43, v47
    .p2align 3
    v_fma_f32 v51, v51, v147, v151
    v_fma_f32 v55, v55, v147, v151
    v_fma_f32 v59, v59, v147, v151
    v_fma_f32 v63, v63, v147, v151
    v_mul_f32 v51, v51, v132
    v_mul_f32 v55, v55, v133
    v_mul_f32 v59, v59, v134
    v_mul_f32 v63, v63, v135
    v_cvt_pk_bf16_f32 v166, v51, v55
    v_cvt_pk_bf16_f32 v167, v59, v63
    ds_write_b128 v7, v[164:167] offset:128
    s_waitcnt lgkmcnt(0)
    s_barrier
    s_waitcnt vmcnt(0)
    ds_read_b128 v[128:131], v21 offset:128
    ds_read_b128 v[132:135], v21 offset:144
    .p2align 3
    v_fma_f32 v64, v64, v144, v148
    v_fma_f32 v68, v68, v144, v148
    v_fma_f32 v72, v72, v144, v148
    v_fma_f32 v76, v76, v144, v148
    v_mul_f32 v64, v64, v136
    v_mul_f32 v68, v68, v137
    v_mul_f32 v72, v72, v138
    v_mul_f32 v76, v76, v139
    v_cvt_pk_bf16_f32 v152, v64, v68
    v_cvt_pk_bf16_f32 v153, v72, v76
    s_mul_i32 s54, s82, 9216
    buffer_load_dwordx4 v[96:99], v168, s[20:23], s54 offen
    buffer_load_dwordx4 v[100:103], v169, s[20:23], s54 offen
    .p2align 3
    v_fma_f32 v80, v80, v144, v148
    v_fma_f32 v84, v84, v144, v148
    v_fma_f32 v88, v88, v144, v148
    v_fma_f32 v92, v92, v144, v148
    v_mul_f32 v80, v80, v140
    v_mul_f32 v84, v84, v141
    v_mul_f32 v88, v88, v142
    v_mul_f32 v92, v92, v143
    v_cvt_pk_bf16_f32 v154, v80, v84
    v_cvt_pk_bf16_f32 v155, v88, v92
    ds_write_b128 v6, v[152:155] offset:16384
    buffer_load_dwordx4 v[104:107], v170, s[20:23], s54 offen
    buffer_load_dwordx4 v[108:111], v171, s[20:23], s54 offen
    .p2align 3
    v_fma_f32 v65, v65, v145, v149
    v_fma_f32 v69, v69, v145, v149
    v_fma_f32 v73, v73, v145, v149
    v_fma_f32 v77, v77, v145, v149
    v_mul_f32 v65, v65, v136
    v_mul_f32 v69, v69, v137
    v_mul_f32 v73, v73, v138
    v_mul_f32 v77, v77, v139
    v_cvt_pk_bf16_f32 v156, v65, v69
    v_cvt_pk_bf16_f32 v157, v73, v77
    buffer_load_dwordx4 v[112:115], v172, s[20:23], s54 offen
    .p2align 3
    v_fma_f32 v81, v81, v145, v149
    v_fma_f32 v85, v85, v145, v149
    v_fma_f32 v89, v89, v145, v149
    v_fma_f32 v93, v93, v145, v149
    v_mul_f32 v81, v81, v140
    v_mul_f32 v85, v85, v141
    v_mul_f32 v89, v89, v142
    v_mul_f32 v93, v93, v143
    v_cvt_pk_bf16_f32 v158, v81, v85
    v_cvt_pk_bf16_f32 v159, v89, v93
    ds_write_b128 v7, v[156:159] offset:16384
    buffer_load_dwordx4 v[116:119], v173, s[20:23], s54 offen
    buffer_load_dwordx4 v[120:123], v174, s[20:23], s54 offen
    .p2align 3
    v_fma_f32 v66, v66, v146, v150
    v_fma_f32 v70, v70, v146, v150
    v_fma_f32 v74, v74, v146, v150
    v_fma_f32 v78, v78, v146, v150
    v_mul_f32 v66, v66, v136
    v_mul_f32 v70, v70, v137
    v_mul_f32 v74, v74, v138
    v_mul_f32 v78, v78, v139
    v_cvt_pk_bf16_f32 v160, v66, v70
    v_cvt_pk_bf16_f32 v161, v74, v78
    buffer_load_dwordx4 v[124:127], v175, s[20:23], s54 offen
    .p2align 3
    v_fma_f32 v82, v82, v146, v150
    v_fma_f32 v86, v86, v146, v150
    v_fma_f32 v90, v90, v146, v150
    v_fma_f32 v94, v94, v146, v150
    v_mul_f32 v82, v82, v140
    v_mul_f32 v86, v86, v141
    v_mul_f32 v90, v90, v142
    v_mul_f32 v94, v94, v143
    v_cvt_pk_bf16_f32 v162, v82, v86
    v_cvt_pk_bf16_f32 v163, v90, v94
    ds_write_b128 v6, v[160:163] offset:16512
    s_mul_i32 s54, s83, 9216
    buffer_load_dwordx4 v[32:35], v168, s[20:23], s54 offen
    buffer_load_dwordx4 v[36:39], v169, s[20:23], s54 offen
    .p2align 3
    v_fma_f32 v67, v67, v147, v151
    v_fma_f32 v71, v71, v147, v151
    v_fma_f32 v75, v75, v147, v151
    v_fma_f32 v79, v79, v147, v151
    v_mul_f32 v67, v67, v136
    v_mul_f32 v71, v71, v137
    v_mul_f32 v75, v75, v138
    v_mul_f32 v79, v79, v139
    v_cvt_pk_bf16_f32 v164, v67, v71
    v_cvt_pk_bf16_f32 v165, v75, v79
    buffer_load_dwordx4 v[40:43], v170, s[20:23], s54 offen
    .p2align 3
    v_fma_f32 v83, v83, v147, v151
    v_fma_f32 v87, v87, v147, v151
    v_fma_f32 v91, v91, v147, v151
    v_fma_f32 v95, v95, v147, v151
    v_mul_f32 v83, v83, v140
    v_mul_f32 v87, v87, v141
    v_mul_f32 v91, v91, v142
    v_mul_f32 v95, v95, v143
    v_cvt_pk_bf16_f32 v166, v83, v87
    v_cvt_pk_bf16_f32 v167, v91, v95
    ds_write_b128 v7, v[164:167] offset:16512
    buffer_load_dwordx4 v[44:47], v171, s[20:23], s54 offen
    s_waitcnt vmcnt(4)
    s_waitcnt lgkmcnt(4)
    .p2align 3
    v_fma_f32 v96, v96, v144, v148
    v_fma_f32 v100, v100, v144, v148
    v_fma_f32 v104, v104, v144, v148
    v_fma_f32 v108, v108, v144, v148
    v_mul_f32 v96, v96, v128
    v_mul_f32 v100, v100, v129
    v_mul_f32 v104, v104, v130
    v_mul_f32 v108, v108, v131
    v_cvt_pk_bf16_f32 v152, v96, v100
    v_cvt_pk_bf16_f32 v153, v104, v108
    buffer_load_dwordx4 v[48:51], v172, s[20:23], s54 offen
    buffer_load_dwordx4 v[52:55], v173, s[20:23], s54 offen
    .p2align 3
    v_fma_f32 v112, v112, v144, v148
    v_fma_f32 v116, v116, v144, v148
    v_fma_f32 v120, v120, v144, v148
    v_fma_f32 v124, v124, v144, v148
    v_mul_f32 v112, v112, v132
    v_mul_f32 v116, v116, v133
    v_mul_f32 v120, v120, v134
    v_mul_f32 v124, v124, v135
    v_cvt_pk_bf16_f32 v154, v112, v116
    v_cvt_pk_bf16_f32 v155, v120, v124
    s_waitcnt lgkmcnt(0)
    s_barrier
    ds_read_b128 v[136:139], v21 offset:192
    ds_read_b128 v[140:143], v21 offset:208
    ds_write_b128 v6, v[152:155] offset:0
    buffer_load_dwordx4 v[56:59], v174, s[20:23], s54 offen
    buffer_load_dwordx4 v[60:63], v175, s[20:23], s54 offen
    .p2align 3
    v_fma_f32 v97, v97, v145, v149
    v_fma_f32 v101, v101, v145, v149
    v_fma_f32 v105, v105, v145, v149
    v_fma_f32 v109, v109, v145, v149
    v_mul_f32 v97, v97, v128
    v_mul_f32 v101, v101, v129
    v_mul_f32 v105, v105, v130
    v_mul_f32 v109, v109, v131
    v_cvt_pk_bf16_f32 v156, v97, v101
    v_cvt_pk_bf16_f32 v157, v105, v109
    s_mul_i32 s54, s84, 9216
    buffer_load_dwordx4 v[64:67], v168, s[20:23], s54 offen
    .p2align 3
    v_fma_f32 v113, v113, v145, v149
    v_fma_f32 v117, v117, v145, v149
    v_fma_f32 v121, v121, v145, v149
    v_fma_f32 v125, v125, v145, v149
    v_mul_f32 v113, v113, v132
    v_mul_f32 v117, v117, v133
    v_mul_f32 v121, v121, v134
    v_mul_f32 v125, v125, v135
    v_cvt_pk_bf16_f32 v158, v113, v117
    v_cvt_pk_bf16_f32 v159, v121, v125
    ds_write_b128 v7, v[156:159] offset:0
    buffer_load_dwordx4 v[68:71], v169, s[20:23], s54 offen
    buffer_load_dwordx4 v[72:75], v170, s[20:23], s54 offen
    .p2align 3
    v_fma_f32 v98, v98, v146, v150
    v_fma_f32 v102, v102, v146, v150
    v_fma_f32 v106, v106, v146, v150
    v_fma_f32 v110, v110, v146, v150
    v_mul_f32 v98, v98, v128
    v_mul_f32 v102, v102, v129
    v_mul_f32 v106, v106, v130
    v_mul_f32 v110, v110, v131
    v_cvt_pk_bf16_f32 v160, v98, v102
    v_cvt_pk_bf16_f32 v161, v106, v110
    buffer_load_dwordx4 v[76:79], v171, s[20:23], s54 offen
    .p2align 3
    v_fma_f32 v114, v114, v146, v150
    v_fma_f32 v118, v118, v146, v150
    v_fma_f32 v122, v122, v146, v150
    v_fma_f32 v126, v126, v146, v150
    v_mul_f32 v114, v114, v132
    v_mul_f32 v118, v118, v133
    v_mul_f32 v122, v122, v134
    v_mul_f32 v126, v126, v135
    v_cvt_pk_bf16_f32 v162, v114, v118
    v_cvt_pk_bf16_f32 v163, v122, v126
    ds_write_b128 v6, v[160:163] offset:128
    buffer_load_dwordx4 v[80:83], v172, s[20:23], s54 offen
    buffer_load_dwordx4 v[84:87], v173, s[20:23], s54 offen
    .p2align 3
    v_fma_f32 v99, v99, v147, v151
    v_fma_f32 v103, v103, v147, v151
    v_fma_f32 v107, v107, v147, v151
    v_fma_f32 v111, v111, v147, v151
    v_mul_f32 v99, v99, v128
    v_mul_f32 v103, v103, v129
    v_mul_f32 v107, v107, v130
    v_mul_f32 v111, v111, v131
    v_cvt_pk_bf16_f32 v164, v99, v103
    v_cvt_pk_bf16_f32 v165, v107, v111
    buffer_load_dwordx4 v[88:91], v174, s[20:23], s54 offen
    .p2align 3
    v_fma_f32 v115, v115, v147, v151
    v_fma_f32 v119, v119, v147, v151
    v_fma_f32 v123, v123, v147, v151
    v_fma_f32 v127, v127, v147, v151
    v_mul_f32 v115, v115, v132
    v_mul_f32 v119, v119, v133
    v_mul_f32 v123, v123, v134
    v_mul_f32 v127, v127, v135
    v_cvt_pk_bf16_f32 v166, v115, v119
    v_cvt_pk_bf16_f32 v167, v123, v127
    ds_write_b128 v7, v[164:167] offset:128
    buffer_load_dwordx4 v[92:95], v175, s[20:23], s54 offen
    s_waitcnt vmcnt(8)
    s_waitcnt lgkmcnt(4)
    .p2align 3
    v_fma_f32 v32, v32, v144, v148
    v_fma_f32 v36, v36, v144, v148
    v_fma_f32 v40, v40, v144, v148
    v_fma_f32 v44, v44, v144, v148
    v_mul_f32 v32, v32, v136
    v_mul_f32 v36, v36, v137
    v_mul_f32 v40, v40, v138
    v_mul_f32 v44, v44, v139
    v_cvt_pk_bf16_f32 v152, v32, v36
    v_cvt_pk_bf16_f32 v153, v40, v44
    s_mul_i32 s54, s85, 9216
    buffer_load_dwordx4 v[96:99], v168, s[20:23], s54 offen
    buffer_load_dwordx4 v[100:103], v169, s[20:23], s54 offen
    .p2align 3
    v_fma_f32 v48, v48, v144, v148
    v_fma_f32 v52, v52, v144, v148
    v_fma_f32 v56, v56, v144, v148
    v_fma_f32 v60, v60, v144, v148
    v_mul_f32 v48, v48, v140
    v_mul_f32 v52, v52, v141
    v_mul_f32 v56, v56, v142
    v_mul_f32 v60, v60, v143
    v_cvt_pk_bf16_f32 v154, v48, v52
    v_cvt_pk_bf16_f32 v155, v56, v60
    s_waitcnt lgkmcnt(0)
    s_barrier
    ds_read_b128 v[128:131], v21 offset:256
    ds_read_b128 v[132:135], v21 offset:272
    ds_write_b128 v6, v[152:155] offset:16384
    buffer_load_dwordx4 v[104:107], v170, s[20:23], s54 offen
    .p2align 3
    v_fma_f32 v33, v33, v145, v149
    v_fma_f32 v37, v37, v145, v149
    v_fma_f32 v41, v41, v145, v149
    v_fma_f32 v45, v45, v145, v149
    v_mul_f32 v33, v33, v136
    v_mul_f32 v37, v37, v137
    v_mul_f32 v41, v41, v138
    v_mul_f32 v45, v45, v139
    v_cvt_pk_bf16_f32 v156, v33, v37
    v_cvt_pk_bf16_f32 v157, v41, v45
    buffer_load_dwordx4 v[108:111], v171, s[20:23], s54 offen
    .p2align 3
    v_fma_f32 v49, v49, v145, v149
    v_fma_f32 v53, v53, v145, v149
    v_fma_f32 v57, v57, v145, v149
    v_fma_f32 v61, v61, v145, v149
    v_mul_f32 v49, v49, v140
    v_mul_f32 v53, v53, v141
    v_mul_f32 v57, v57, v142
    v_mul_f32 v61, v61, v143
    v_cvt_pk_bf16_f32 v158, v49, v53
    v_cvt_pk_bf16_f32 v159, v57, v61
    ds_write_b128 v7, v[156:159] offset:16384
    buffer_load_dwordx4 v[112:115], v172, s[20:23], s54 offen
    .p2align 3
    v_fma_f32 v34, v34, v146, v150
    v_fma_f32 v38, v38, v146, v150
    v_fma_f32 v42, v42, v146, v150
    v_fma_f32 v46, v46, v146, v150
    v_mul_f32 v34, v34, v136
    v_mul_f32 v38, v38, v137
    v_mul_f32 v42, v42, v138
    v_mul_f32 v46, v46, v139
    v_cvt_pk_bf16_f32 v160, v34, v38
    v_cvt_pk_bf16_f32 v161, v42, v46
    buffer_load_dwordx4 v[116:119], v173, s[20:23], s54 offen
    .p2align 3
    v_fma_f32 v50, v50, v146, v150
    v_fma_f32 v54, v54, v146, v150
    v_fma_f32 v58, v58, v146, v150
    v_fma_f32 v62, v62, v146, v150
    v_mul_f32 v50, v50, v140
    v_mul_f32 v54, v54, v141
    v_mul_f32 v58, v58, v142
    v_mul_f32 v62, v62, v143
    v_cvt_pk_bf16_f32 v162, v50, v54
    v_cvt_pk_bf16_f32 v163, v58, v62
    ds_write_b128 v6, v[160:163] offset:16512
    buffer_load_dwordx4 v[120:123], v174, s[20:23], s54 offen
    .p2align 3
    v_fma_f32 v35, v35, v147, v151
    v_fma_f32 v39, v39, v147, v151
    v_fma_f32 v43, v43, v147, v151
    v_fma_f32 v47, v47, v147, v151
    v_mul_f32 v35, v35, v136
    v_mul_f32 v39, v39, v137
    v_mul_f32 v43, v43, v138
    v_mul_f32 v47, v47, v139
    v_cvt_pk_bf16_f32 v164, v35, v39
    v_cvt_pk_bf16_f32 v165, v43, v47
    buffer_load_dwordx4 v[124:127], v175, s[20:23], s54 offen
    .p2align 3
    v_fma_f32 v51, v51, v147, v151
    v_fma_f32 v55, v55, v147, v151
    v_fma_f32 v59, v59, v147, v151
    v_fma_f32 v63, v63, v147, v151
    v_mul_f32 v51, v51, v140
    v_mul_f32 v55, v55, v141
    v_mul_f32 v59, v59, v142
    v_mul_f32 v63, v63, v143
    v_cvt_pk_bf16_f32 v166, v51, v55
    v_cvt_pk_bf16_f32 v167, v59, v63
    ds_write_b128 v7, v[164:167] offset:16512
    s_waitcnt vmcnt(8)
    s_waitcnt lgkmcnt(4)
    .p2align 3
    v_fma_f32 v64, v64, v144, v148
    v_fma_f32 v68, v68, v144, v148
    v_fma_f32 v72, v72, v144, v148
    v_fma_f32 v76, v76, v144, v148
    v_mul_f32 v64, v64, v128
    v_mul_f32 v68, v68, v129
    v_mul_f32 v72, v72, v130
    v_mul_f32 v76, v76, v131
    v_cvt_pk_bf16_f32 v152, v64, v68
    v_cvt_pk_bf16_f32 v153, v72, v76
    s_mul_i32 s54, s86, 9216
    buffer_load_dwordx4 v[32:35], v168, s[20:23], s54 offen
    buffer_load_dwordx4 v[36:39], v169, s[20:23], s54 offen
    .p2align 3
    v_fma_f32 v80, v80, v144, v148
    v_fma_f32 v84, v84, v144, v148
    v_fma_f32 v88, v88, v144, v148
    v_fma_f32 v92, v92, v144, v148
    v_mul_f32 v80, v80, v132
    v_mul_f32 v84, v84, v133
    v_mul_f32 v88, v88, v134
    v_mul_f32 v92, v92, v135
    v_cvt_pk_bf16_f32 v154, v80, v84
    v_cvt_pk_bf16_f32 v155, v88, v92
    s_waitcnt lgkmcnt(0)
    s_barrier
    ds_read_b128 v[136:139], v21 offset:320
    ds_read_b128 v[140:143], v21 offset:336
    ds_write_b128 v6, v[152:155] offset:0
    buffer_load_dwordx4 v[40:43], v170, s[20:23], s54 offen
    .p2align 3
    v_fma_f32 v65, v65, v145, v149
    v_fma_f32 v69, v69, v145, v149
    v_fma_f32 v73, v73, v145, v149
    v_fma_f32 v77, v77, v145, v149
    v_mul_f32 v65, v65, v128
    v_mul_f32 v69, v69, v129
    v_mul_f32 v73, v73, v130
    v_mul_f32 v77, v77, v131
    v_cvt_pk_bf16_f32 v156, v65, v69
    v_cvt_pk_bf16_f32 v157, v73, v77
    buffer_load_dwordx4 v[44:47], v171, s[20:23], s54 offen
    .p2align 3
    v_fma_f32 v81, v81, v145, v149
    v_fma_f32 v85, v85, v145, v149
    v_fma_f32 v89, v89, v145, v149
    v_fma_f32 v93, v93, v145, v149
    v_mul_f32 v81, v81, v132
    v_mul_f32 v85, v85, v133
    v_mul_f32 v89, v89, v134
    v_mul_f32 v93, v93, v135
    v_cvt_pk_bf16_f32 v158, v81, v85
    v_cvt_pk_bf16_f32 v159, v89, v93
    ds_write_b128 v7, v[156:159] offset:0
    buffer_load_dwordx4 v[48:51], v172, s[20:23], s54 offen
    .p2align 3
    v_fma_f32 v66, v66, v146, v150
    v_fma_f32 v70, v70, v146, v150
    v_fma_f32 v74, v74, v146, v150
    v_fma_f32 v78, v78, v146, v150
    v_mul_f32 v66, v66, v128
    v_mul_f32 v70, v70, v129
    v_mul_f32 v74, v74, v130
    v_mul_f32 v78, v78, v131
    v_cvt_pk_bf16_f32 v160, v66, v70
    v_cvt_pk_bf16_f32 v161, v74, v78
    buffer_load_dwordx4 v[52:55], v173, s[20:23], s54 offen
    .p2align 3
    v_fma_f32 v82, v82, v146, v150
    v_fma_f32 v86, v86, v146, v150
    v_fma_f32 v90, v90, v146, v150
    v_fma_f32 v94, v94, v146, v150
    v_mul_f32 v82, v82, v132
    v_mul_f32 v86, v86, v133
    v_mul_f32 v90, v90, v134
    v_mul_f32 v94, v94, v135
    v_cvt_pk_bf16_f32 v162, v82, v86
    v_cvt_pk_bf16_f32 v163, v90, v94
    ds_write_b128 v6, v[160:163] offset:128
    buffer_load_dwordx4 v[56:59], v174, s[20:23], s54 offen
    .p2align 3
    v_fma_f32 v67, v67, v147, v151
    v_fma_f32 v71, v71, v147, v151
    v_fma_f32 v75, v75, v147, v151
    v_fma_f32 v79, v79, v147, v151
    v_mul_f32 v67, v67, v128
    v_mul_f32 v71, v71, v129
    v_mul_f32 v75, v75, v130
    v_mul_f32 v79, v79, v131
    v_cvt_pk_bf16_f32 v164, v67, v71
    v_cvt_pk_bf16_f32 v165, v75, v79
    buffer_load_dwordx4 v[60:63], v175, s[20:23], s54 offen
    .p2align 3
    v_fma_f32 v83, v83, v147, v151
    v_fma_f32 v87, v87, v147, v151
    v_fma_f32 v91, v91, v147, v151
    v_fma_f32 v95, v95, v147, v151
    v_mul_f32 v83, v83, v132
    v_mul_f32 v87, v87, v133
    v_mul_f32 v91, v91, v134
    v_mul_f32 v95, v95, v135
    v_cvt_pk_bf16_f32 v166, v83, v87
    v_cvt_pk_bf16_f32 v167, v91, v95
    ds_write_b128 v7, v[164:167] offset:128
    s_waitcnt vmcnt(8)
    s_waitcnt lgkmcnt(4)
    .p2align 3
    v_fma_f32 v96, v96, v144, v148
    v_fma_f32 v100, v100, v144, v148
    v_fma_f32 v104, v104, v144, v148
    v_fma_f32 v108, v108, v144, v148
    v_mul_f32 v96, v96, v136
    v_mul_f32 v100, v100, v137
    v_mul_f32 v104, v104, v138
    v_mul_f32 v108, v108, v139
    v_cvt_pk_bf16_f32 v152, v96, v100
    v_cvt_pk_bf16_f32 v153, v104, v108
    s_mul_i32 s54, s87, 9216
    buffer_load_dwordx4 v[64:67], v168, s[20:23], s54 offen
    buffer_load_dwordx4 v[68:71], v169, s[20:23], s54 offen
    .p2align 3
    v_fma_f32 v112, v112, v144, v148
    v_fma_f32 v116, v116, v144, v148
    v_fma_f32 v120, v120, v144, v148
    v_fma_f32 v124, v124, v144, v148
    v_mul_f32 v112, v112, v140
    v_mul_f32 v116, v116, v141
    v_mul_f32 v120, v120, v142
    v_mul_f32 v124, v124, v143
    v_cvt_pk_bf16_f32 v154, v112, v116
    v_cvt_pk_bf16_f32 v155, v120, v124
    s_waitcnt lgkmcnt(0)
    s_barrier
    ds_read_b128 v[128:131], v21 offset:384
    ds_read_b128 v[132:135], v21 offset:400
    ds_write_b128 v6, v[152:155] offset:16384
    buffer_load_dwordx4 v[72:75], v170, s[20:23], s54 offen
    .p2align 3
    v_fma_f32 v97, v97, v145, v149
    v_fma_f32 v101, v101, v145, v149
    v_fma_f32 v105, v105, v145, v149
    v_fma_f32 v109, v109, v145, v149
    v_mul_f32 v97, v97, v136
    v_mul_f32 v101, v101, v137
    v_mul_f32 v105, v105, v138
    v_mul_f32 v109, v109, v139
    v_cvt_pk_bf16_f32 v156, v97, v101
    v_cvt_pk_bf16_f32 v157, v105, v109
    buffer_load_dwordx4 v[76:79], v171, s[20:23], s54 offen
    .p2align 3
    v_fma_f32 v113, v113, v145, v149
    v_fma_f32 v117, v117, v145, v149
    v_fma_f32 v121, v121, v145, v149
    v_fma_f32 v125, v125, v145, v149
    v_mul_f32 v113, v113, v140
    v_mul_f32 v117, v117, v141
    v_mul_f32 v121, v121, v142
    v_mul_f32 v125, v125, v143
    v_cvt_pk_bf16_f32 v158, v113, v117
    v_cvt_pk_bf16_f32 v159, v121, v125
    ds_write_b128 v7, v[156:159] offset:16384
    buffer_load_dwordx4 v[80:83], v172, s[20:23], s54 offen
    .p2align 3
    v_fma_f32 v98, v98, v146, v150
    v_fma_f32 v102, v102, v146, v150
    v_fma_f32 v106, v106, v146, v150
    v_fma_f32 v110, v110, v146, v150
    v_mul_f32 v98, v98, v136
    v_mul_f32 v102, v102, v137
    v_mul_f32 v106, v106, v138
    v_mul_f32 v110, v110, v139
    v_cvt_pk_bf16_f32 v160, v98, v102
    v_cvt_pk_bf16_f32 v161, v106, v110
    buffer_load_dwordx4 v[84:87], v173, s[20:23], s54 offen
    .p2align 3
    v_fma_f32 v114, v114, v146, v150
    v_fma_f32 v118, v118, v146, v150
    v_fma_f32 v122, v122, v146, v150
    v_fma_f32 v126, v126, v146, v150
    v_mul_f32 v114, v114, v140
    v_mul_f32 v118, v118, v141
    v_mul_f32 v122, v122, v142
    v_mul_f32 v126, v126, v143
    v_cvt_pk_bf16_f32 v162, v114, v118
    v_cvt_pk_bf16_f32 v163, v122, v126
    ds_write_b128 v6, v[160:163] offset:16512
    buffer_load_dwordx4 v[88:91], v174, s[20:23], s54 offen
    .p2align 3
    v_fma_f32 v99, v99, v147, v151
    v_fma_f32 v103, v103, v147, v151
    v_fma_f32 v107, v107, v147, v151
    v_fma_f32 v111, v111, v147, v151
    v_mul_f32 v99, v99, v136
    v_mul_f32 v103, v103, v137
    v_mul_f32 v107, v107, v138
    v_mul_f32 v111, v111, v139
    v_cvt_pk_bf16_f32 v164, v99, v103
    v_cvt_pk_bf16_f32 v165, v107, v111
    buffer_load_dwordx4 v[92:95], v175, s[20:23], s54 offen
    .p2align 3
    v_fma_f32 v115, v115, v147, v151
    v_fma_f32 v119, v119, v147, v151
    v_fma_f32 v123, v123, v147, v151
    v_fma_f32 v127, v127, v147, v151
    v_mul_f32 v115, v115, v140
    v_mul_f32 v119, v119, v141
    v_mul_f32 v123, v123, v142
    v_mul_f32 v127, v127, v143
    v_cvt_pk_bf16_f32 v166, v115, v119
    v_cvt_pk_bf16_f32 v167, v123, v127
    ds_write_b128 v7, v[164:167] offset:16512
    s_waitcnt vmcnt(8)
    s_waitcnt lgkmcnt(4)
    .p2align 3
    v_fma_f32 v32, v32, v144, v148
    v_fma_f32 v36, v36, v144, v148
    v_fma_f32 v40, v40, v144, v148
    v_fma_f32 v44, v44, v144, v148
    v_mul_f32 v32, v32, v128
    v_mul_f32 v36, v36, v129
    v_mul_f32 v40, v40, v130
    v_mul_f32 v44, v44, v131
    v_cvt_pk_bf16_f32 v152, v32, v36
    v_cvt_pk_bf16_f32 v153, v40, v44
    s_mul_i32 s54, s88, 9216
    buffer_load_dwordx4 v[96:99], v168, s[20:23], s54 offen
    buffer_load_dwordx4 v[100:103], v169, s[20:23], s54 offen
    .p2align 3
    v_fma_f32 v48, v48, v144, v148
    v_fma_f32 v52, v52, v144, v148
    v_fma_f32 v56, v56, v144, v148
    v_fma_f32 v60, v60, v144, v148
    v_mul_f32 v48, v48, v132
    v_mul_f32 v52, v52, v133
    v_mul_f32 v56, v56, v134
    v_mul_f32 v60, v60, v135
    v_cvt_pk_bf16_f32 v154, v48, v52
    v_cvt_pk_bf16_f32 v155, v56, v60
    s_waitcnt lgkmcnt(0)
    s_barrier
    ds_read_b128 v[136:139], v21 offset:448
    ds_read_b128 v[140:143], v21 offset:464
    ds_write_b128 v6, v[152:155] offset:0
    buffer_load_dwordx4 v[104:107], v170, s[20:23], s54 offen
    .p2align 3
    v_fma_f32 v33, v33, v145, v149
    v_fma_f32 v37, v37, v145, v149
    v_fma_f32 v41, v41, v145, v149
    v_fma_f32 v45, v45, v145, v149
    v_mul_f32 v33, v33, v128
    v_mul_f32 v37, v37, v129
    v_mul_f32 v41, v41, v130
    v_mul_f32 v45, v45, v131
    v_cvt_pk_bf16_f32 v156, v33, v37
    v_cvt_pk_bf16_f32 v157, v41, v45
    buffer_load_dwordx4 v[108:111], v171, s[20:23], s54 offen
    .p2align 3
    v_fma_f32 v49, v49, v145, v149
    v_fma_f32 v53, v53, v145, v149
    v_fma_f32 v57, v57, v145, v149
    v_fma_f32 v61, v61, v145, v149
    v_mul_f32 v49, v49, v132
    v_mul_f32 v53, v53, v133
    v_mul_f32 v57, v57, v134
    v_mul_f32 v61, v61, v135
    v_cvt_pk_bf16_f32 v158, v49, v53
    v_cvt_pk_bf16_f32 v159, v57, v61
    ds_write_b128 v7, v[156:159] offset:0
    buffer_load_dwordx4 v[112:115], v172, s[20:23], s54 offen
    .p2align 3
    v_fma_f32 v34, v34, v146, v150
    v_fma_f32 v38, v38, v146, v150
    v_fma_f32 v42, v42, v146, v150
    v_fma_f32 v46, v46, v146, v150
    v_mul_f32 v34, v34, v128
    v_mul_f32 v38, v38, v129
    v_mul_f32 v42, v42, v130
    v_mul_f32 v46, v46, v131
    v_cvt_pk_bf16_f32 v160, v34, v38
    v_cvt_pk_bf16_f32 v161, v42, v46
    buffer_load_dwordx4 v[116:119], v173, s[20:23], s54 offen
    .p2align 3
    v_fma_f32 v50, v50, v146, v150
    v_fma_f32 v54, v54, v146, v150
    v_fma_f32 v58, v58, v146, v150
    v_fma_f32 v62, v62, v146, v150
    v_mul_f32 v50, v50, v132
    v_mul_f32 v54, v54, v133
    v_mul_f32 v58, v58, v134
    v_mul_f32 v62, v62, v135
    v_cvt_pk_bf16_f32 v162, v50, v54
    v_cvt_pk_bf16_f32 v163, v58, v62
    ds_write_b128 v6, v[160:163] offset:128
    buffer_load_dwordx4 v[120:123], v174, s[20:23], s54 offen
    .p2align 3
    v_fma_f32 v35, v35, v147, v151
    v_fma_f32 v39, v39, v147, v151
    v_fma_f32 v43, v43, v147, v151
    v_fma_f32 v47, v47, v147, v151
    v_mul_f32 v35, v35, v128
    v_mul_f32 v39, v39, v129
    v_mul_f32 v43, v43, v130
    v_mul_f32 v47, v47, v131
    v_cvt_pk_bf16_f32 v164, v35, v39
    v_cvt_pk_bf16_f32 v165, v43, v47
    buffer_load_dwordx4 v[124:127], v175, s[20:23], s54 offen
    .p2align 3
    v_fma_f32 v51, v51, v147, v151
    v_fma_f32 v55, v55, v147, v151
    v_fma_f32 v59, v59, v147, v151
    v_fma_f32 v63, v63, v147, v151
    v_mul_f32 v51, v51, v132
    v_mul_f32 v55, v55, v133
    v_mul_f32 v59, v59, v134
    v_mul_f32 v63, v63, v135
    v_cvt_pk_bf16_f32 v166, v51, v55
    v_cvt_pk_bf16_f32 v167, v59, v63
    ds_write_b128 v7, v[164:167] offset:128
    s_waitcnt vmcnt(8)
    s_waitcnt lgkmcnt(4)
    .p2align 3
    v_fma_f32 v64, v64, v144, v148
    v_fma_f32 v68, v68, v144, v148
    v_fma_f32 v72, v72, v144, v148
    v_fma_f32 v76, v76, v144, v148
    v_mul_f32 v64, v64, v136
    v_mul_f32 v68, v68, v137
    v_mul_f32 v72, v72, v138
    v_mul_f32 v76, v76, v139
    v_cvt_pk_bf16_f32 v152, v64, v68
    v_cvt_pk_bf16_f32 v153, v72, v76
    .p2align 3
    v_fma_f32 v80, v80, v144, v148
    v_fma_f32 v84, v84, v144, v148
    v_fma_f32 v88, v88, v144, v148
    v_fma_f32 v92, v92, v144, v148
    v_mul_f32 v80, v80, v140
    v_mul_f32 v84, v84, v141
    v_mul_f32 v88, v88, v142
    v_mul_f32 v92, v92, v143
    v_cvt_pk_bf16_f32 v154, v80, v84
    v_cvt_pk_bf16_f32 v155, v88, v92
    s_waitcnt lgkmcnt(0)
    s_barrier
    ds_read_b128 v[128:131], v21 offset:512
    ds_read_b128 v[132:135], v21 offset:528
    ds_write_b128 v6, v[152:155] offset:16384
    .p2align 3
    v_fma_f32 v65, v65, v145, v149
    v_fma_f32 v69, v69, v145, v149
    v_fma_f32 v73, v73, v145, v149
    v_fma_f32 v77, v77, v145, v149
    v_mul_f32 v65, v65, v136
    v_mul_f32 v69, v69, v137
    v_mul_f32 v73, v73, v138
    v_mul_f32 v77, v77, v139
    v_cvt_pk_bf16_f32 v156, v65, v69
    v_cvt_pk_bf16_f32 v157, v73, v77
    .p2align 3
    v_fma_f32 v81, v81, v145, v149
    v_fma_f32 v85, v85, v145, v149
    v_fma_f32 v89, v89, v145, v149
    v_fma_f32 v93, v93, v145, v149
    v_mul_f32 v81, v81, v140
    v_mul_f32 v85, v85, v141
    v_mul_f32 v89, v89, v142
    v_mul_f32 v93, v93, v143
    v_cvt_pk_bf16_f32 v158, v81, v85
    v_cvt_pk_bf16_f32 v159, v89, v93
    ds_write_b128 v7, v[156:159] offset:16384
    .p2align 3
    v_fma_f32 v66, v66, v146, v150
    v_fma_f32 v70, v70, v146, v150
    v_fma_f32 v74, v74, v146, v150
    v_fma_f32 v78, v78, v146, v150
    v_mul_f32 v66, v66, v136
    v_mul_f32 v70, v70, v137
    v_mul_f32 v74, v74, v138
    v_mul_f32 v78, v78, v139
    v_cvt_pk_bf16_f32 v160, v66, v70
    v_cvt_pk_bf16_f32 v161, v74, v78
    .p2align 3
    v_fma_f32 v82, v82, v146, v150
    v_fma_f32 v86, v86, v146, v150
    v_fma_f32 v90, v90, v146, v150
    v_fma_f32 v94, v94, v146, v150
    v_mul_f32 v82, v82, v140
    v_mul_f32 v86, v86, v141
    v_mul_f32 v90, v90, v142
    v_mul_f32 v94, v94, v143
    v_cvt_pk_bf16_f32 v162, v82, v86
    v_cvt_pk_bf16_f32 v163, v90, v94
    ds_write_b128 v6, v[160:163] offset:16512
    .p2align 3
    v_fma_f32 v67, v67, v147, v151
    v_fma_f32 v71, v71, v147, v151
    v_fma_f32 v75, v75, v147, v151
    v_fma_f32 v79, v79, v147, v151
    v_mul_f32 v67, v67, v136
    v_mul_f32 v71, v71, v137
    v_mul_f32 v75, v75, v138
    v_mul_f32 v79, v79, v139
    v_cvt_pk_bf16_f32 v164, v67, v71
    v_cvt_pk_bf16_f32 v165, v75, v79
    .p2align 3
    v_fma_f32 v83, v83, v147, v151
    v_fma_f32 v87, v87, v147, v151
    v_fma_f32 v91, v91, v147, v151
    v_fma_f32 v95, v95, v147, v151
    v_mul_f32 v83, v83, v140
    v_mul_f32 v87, v87, v141
    v_mul_f32 v91, v91, v142
    v_mul_f32 v95, v95, v143
    v_cvt_pk_bf16_f32 v166, v83, v87
    v_cvt_pk_bf16_f32 v167, v91, v95
    ds_write_b128 v7, v[164:167] offset:16512
    s_waitcnt vmcnt(0)
    s_waitcnt lgkmcnt(4)
    .p2align 3
    v_fma_f32 v96, v96, v144, v148
    v_fma_f32 v100, v100, v144, v148
    v_fma_f32 v104, v104, v144, v148
    v_fma_f32 v108, v108, v144, v148
    v_mul_f32 v96, v96, v128
    v_mul_f32 v100, v100, v129
    v_mul_f32 v104, v104, v130
    v_mul_f32 v108, v108, v131
    v_cvt_pk_bf16_f32 v152, v96, v100
    v_cvt_pk_bf16_f32 v153, v104, v108
    .p2align 3
    v_fma_f32 v112, v112, v144, v148
    v_fma_f32 v116, v116, v144, v148
    v_fma_f32 v120, v120, v144, v148
    v_fma_f32 v124, v124, v144, v148
    v_mul_f32 v112, v112, v132
    v_mul_f32 v116, v116, v133
    v_mul_f32 v120, v120, v134
    v_mul_f32 v124, v124, v135
    v_cvt_pk_bf16_f32 v154, v112, v116
    v_cvt_pk_bf16_f32 v155, v120, v124
    s_waitcnt lgkmcnt(0)
    s_barrier
    ds_write_b128 v6, v[152:155] offset:0
    .p2align 3
    v_fma_f32 v97, v97, v145, v149
    v_fma_f32 v101, v101, v145, v149
    v_fma_f32 v105, v105, v145, v149
    v_fma_f32 v109, v109, v145, v149
    v_mul_f32 v97, v97, v128
    v_mul_f32 v101, v101, v129
    v_mul_f32 v105, v105, v130
    v_mul_f32 v109, v109, v131
    v_cvt_pk_bf16_f32 v156, v97, v101
    v_cvt_pk_bf16_f32 v157, v105, v109
    s_cmp_ge_u32 s3, 2
    s_cselect_b32 s52, s81, s80
    s_add_u32 m0, s53, 49152
    s_add_u32 s52, s52, s95
    s_add_u32 s52, s52, 221184
    buffer_load_dwordx4 v3, s[16:19], s52 offen lds
    .p2align 3
    v_fma_f32 v113, v113, v145, v149
    v_fma_f32 v117, v117, v145, v149
    v_fma_f32 v121, v121, v145, v149
    v_fma_f32 v125, v125, v145, v149
    v_mul_f32 v113, v113, v132
    v_mul_f32 v117, v117, v133
    v_mul_f32 v121, v121, v134
    v_mul_f32 v125, v125, v135
    v_cvt_pk_bf16_f32 v158, v113, v117
    v_cvt_pk_bf16_f32 v159, v121, v125
    ds_write_b128 v7, v[156:159] offset:0
    s_cmp_ge_u32 s3, 2
    s_cselect_b32 s52, s83, s82
    s_add_u32 m0, s53, 53248
    s_add_u32 s52, s52, s95
    s_add_u32 s52, s52, 221184
    buffer_load_dwordx4 v3, s[16:19], s52 offen lds
    .p2align 3
    v_fma_f32 v98, v98, v146, v150
    v_fma_f32 v102, v102, v146, v150
    v_fma_f32 v106, v106, v146, v150
    v_fma_f32 v110, v110, v146, v150
    v_mul_f32 v98, v98, v128
    v_mul_f32 v102, v102, v129
    v_mul_f32 v106, v106, v130
    v_mul_f32 v110, v110, v131
    v_cvt_pk_bf16_f32 v160, v98, v102
    v_cvt_pk_bf16_f32 v161, v106, v110
    s_cmp_ge_u32 s3, 2
    s_cselect_b32 s52, s85, s84
    s_add_u32 m0, s53, 57344
    s_add_u32 s52, s52, s95
    s_add_u32 s52, s52, 221184
    buffer_load_dwordx4 v3, s[16:19], s52 offen lds
    .p2align 3
    v_fma_f32 v114, v114, v146, v150
    v_fma_f32 v118, v118, v146, v150
    v_fma_f32 v122, v122, v146, v150
    v_fma_f32 v126, v126, v146, v150
    v_mul_f32 v114, v114, v132
    v_mul_f32 v118, v118, v133
    v_mul_f32 v122, v122, v134
    v_mul_f32 v126, v126, v135
    v_cvt_pk_bf16_f32 v162, v114, v118
    v_cvt_pk_bf16_f32 v163, v122, v126
    ds_write_b128 v6, v[160:163] offset:128
    s_cmp_ge_u32 s3, 2
    s_cselect_b32 s52, s87, s86
    s_add_u32 m0, s53, 61440
    s_add_u32 s52, s52, s95
    s_add_u32 s52, s52, 221184
    buffer_load_dwordx4 v3, s[16:19], s52 offen lds
    .p2align 3
    v_fma_f32 v99, v99, v147, v151
    v_fma_f32 v103, v103, v147, v151
    v_fma_f32 v107, v107, v147, v151
    v_fma_f32 v111, v111, v147, v151
    v_mul_f32 v99, v99, v128
    v_mul_f32 v103, v103, v129
    v_mul_f32 v107, v107, v130
    v_mul_f32 v111, v111, v131
    v_cvt_pk_bf16_f32 v164, v99, v103
    v_cvt_pk_bf16_f32 v165, v107, v111
    s_cmp_ge_u32 s3, 2
    s_cbranch_scc1 L_sk1
    s_cmp_ge_u32 s3, 2
    s_cselect_b32 s52, s88, s88
    s_add_u32 m0, s53, 65536
    s_add_u32 s52, s52, s95
    s_add_u32 s52, s52, 221184
    buffer_load_dwordx4 v3, s[16:19], s52 offen lds
L_sk1:
    .p2align 3
    v_fma_f32 v115, v115, v147, v151
    v_fma_f32 v119, v119, v147, v151
    v_fma_f32 v123, v123, v147, v151
    v_fma_f32 v127, v127, v147, v151
    v_mul_f32 v115, v115, v132
    v_mul_f32 v119, v119, v133
    v_mul_f32 v123, v123, v134
    v_mul_f32 v127, v127, v135
    v_cvt_pk_bf16_f32 v166, v115, v119
    v_cvt_pk_bf16_f32 v167, v123, v127
    ds_write_b128 v7, v[164:167] offset:128
    s_waitcnt lgkmcnt(0)
    s_barrier
    s_cmp_ge_u32 s3, 2
    s_cselect_b32 s52, s81, s80
    s_add_u32 m0, s53, 67584
    s_add_u32 s52, s52, s95
    s_add_u32 s52, s52, 239616
    buffer_load_dwordx4 v3, s[16:19], s52 offen lds
    s_cmp_ge_u32 s3, 2
    s_cselect_b32 s52, s83, s82
    s_add_u32 m0, s53, 71680
    s_add_u32 s52, s52, s95
    s_add_u32 s52, s52, 239616
    buffer_load_dwordx4 v3, s[16:19], s52 offen lds
    s_cmp_ge_u32 s3, 2
    s_cselect_b32 s52, s85, s84
    s_add_u32 m0, s53, 75776
    s_add_u32 s52, s52, s95
    s_add_u32 s52, s52, 239616
    buffer_load_dwordx4 v3, s[16:19], s52 offen lds
    s_cmp_ge_u32 s3, 2
    s_cselect_b32 s52, s87, s86
    s_add_u32 m0, s53, 79872
    s_add_u32 s52, s52, s95
    s_add_u32 s52, s52, 239616
    buffer_load_dwordx4 v3, s[16:19], s52 offen lds
    s_cmp_ge_u32 s3, 2
    s_cbranch_scc1 L_sk2
    s_cmp_ge_u32 s3, 2
    s_cselect_b32 s52, s88, s88
    s_add_u32 m0, s53, 83968
    s_add_u32 s52, s52, s95
    s_add_u32 s52, s52, 239616
    buffer_load_dwordx4 v3, s[16:19], s52 offen lds
L_sk2:
    v_lshlrev_b32 v28, 4, v0
    v_add_u32 v28, s55, v28
    v_add_u32 v29, 126976, v28
    v_add_u32 v28, 88064, v28
    s_add_u32 s52, s80, 258048
    buffer_load_dwordx4 v[32:35], v3, s[16:19], s52 offen
    s_add_u32 s52, s81, 258048
    buffer_load_dwordx4 v[36:39], v3, s[16:19], s52 offen
    s_add_u32 s52, s82, 258048
    buffer_load_dwordx4 v[40:43], v3, s[16:19], s52 offen
    s_add_u32 s52, s83, 258048
    buffer_load_dwordx4 v[44:47], v3, s[16:19], s52 offen
    s_add_u32 s52, s84, 258048
    buffer_load_dwordx4 v[48:51], v3, s[16:19], s52 offen
    s_add_u32 s52, s85, 258048
    buffer_load_dwordx4 v[52:55], v3, s[16:19], s52 offen
    s_add_u32 s52, s86, 258048
    buffer_load_dwordx4 v[56:59], v3, s[16:19], s52 offen
    s_add_u32 s52, s87, 258048
    buffer_load_dwordx4 v[60:63], v3, s[16:19], s52 offen
    s_add_u32 s52, s88, 258048
    buffer_load_dwordx4 v[64:67], v3, s[16:19], s52 offen
    s_barrier
    ds_read_b128 v[104:107], v8 offset:16384
    ds_read_b128 v[108:111], v8 offset:20480
    ds_read_b128 v[112:115], v8 offset:24576
    s_add_u32 s52, s80, 294912
    buffer_load_dwordx4 v[68:71], v3, s[16:19], s52 offen
    s_add_u32 s52, s81, 294912
    buffer_load_dwordx4 v[72:75], v3, s[16:19], s52 offen
    s_add_u32 s52, s82, 294912
    buffer_load_dwordx4 v[76:79], v3, s[16:19], s52 offen
    s_add_u32 s52, s83, 294912
    buffer_load_dwordx4 v[80:83], v3, s[16:19], s52 offen
    s_add_u32 s52, s84, 294912
    buffer_load_dwordx4 v[84:87], v3, s[16:19], s52 offen
    s_add_u32 s52, s85, 294912
    buffer_load_dwordx4 v[88:91], v3, s[16:19], s52 offen
    s_add_u32 s52, s86, 294912
    buffer_load_dwordx4 v[92:95], v3, s[16:19], s52 offen
    s_add_u32 s52, s87, 294912
    buffer_load_dwordx4 v[96:99], v3, s[16:19], s52 offen
    s_add_u32 s52, s88, 294912
    buffer_load_dwordx4 v[100:103], v3, s[16:19], s52 offen
    s_waitcnt vmcnt(18)
    s_waitcnt lgkmcnt(2)
    s_mov_b32 s52, 0
    buffer_store_dwordx4 v[104:107], v9, s[36:39], s52 offen sc1
    s_waitcnt lgkmcnt(1)
    s_mov_b32 s52, 147456
    buffer_store_dwordx4 v[108:111], v9, s[36:39], s52 offen sc1
    s_waitcnt lgkmcnt(0)
    s_mov_b32 s52, 294912
    buffer_store_dwordx4 v[112:115], v9, s[36:39], s52 offen sc1
    s_barrier
    ds_read_b128 v[116:119], v8 offset:0
    ds_read_b128 v[120:123], v8 offset:4096
    ds_read_b128 v[124:127], v8 offset:8192
    ds_read_b128 v[128:131], v8 offset:12288
    ds_read_b128 v[132:135], v8 offset:36864
    ds_read_b128 v[136:139], v8 offset:40960
    ds_read_b128 v[140:143], v8 offset:32768
    ds_read_b128 v[144:147], v8 offset:28672
    ds_read_b128 v[148:151], v8 offset:45056
    s_waitcnt lgkmcnt(8)
    s_mov_b32 s52, 442368
    buffer_store_dwordx4 v[116:119], v9, s[36:39], s52 offen sc1
    s_waitcnt vmcnt(13)
    ds_write_b128 v28, v[32:35] offset:0
    ds_write_b128 v28, v[36:39] offset:2048
    s_waitcnt lgkmcnt(9)
    s_mov_b32 s52, 589824
    buffer_store_dwordx4 v[120:123], v9, s[36:39], s52 offen sc1
    ds_write_b128 v28, v[40:43] offset:4096
    s_waitcnt lgkmcnt(9)
    s_cmp_eq_u32 s45, 6
    s_cselect_b32 s50, 2, 1
    s_cmp_ge_u32 s3, s50
    s_cbranch_scc1 L_sk3
    s_mov_b32 s52, 2654208
    buffer_store_dwordx4 v[124:127], v9, s[36:39], s52 offen sc1
L_sk3:
    ds_write_b128 v28, v[44:47] offset:6144
    ds_write_b128 v28, v[48:51] offset:8192
    s_waitcnt lgkmcnt(10)
    s_mov_b32 s52, 737280
    buffer_store_dwordx4 v[128:131], v9, s[36:39], s52 offen sc1
    ds_write_b128 v28, v[52:55] offset:10240
    s_waitcnt lgkmcnt(10)
    s_mov_b32 s52, 884736
    buffer_store_dwordx4 v[132:135], v9, s[36:39], s52 offen sc1
    ds_write_b128 v28, v[56:59] offset:12288
    ds_write_b128 v28, v[60:63] offset:14336
    s_waitcnt lgkmcnt(11)
    s_mov_b32 s52, 1032192
    buffer_store_dwordx4 v[136:139], v9, s[36:39], s52 offen sc1
    ds_write_b128 v28, v[64:67] offset:16384
    s_waitcnt lgkmcnt(0)
    s_barrier
    ds_read_b128 v[152:155], v8 offset:16384
    ds_read_b128 v[156:159], v8 offset:20480
    s_mov_b32 s52, 1179648
    buffer_store_dwordx4 v[140:143], v9, s[36:39], s52 offen sc1
    s_waitcnt vmcnt(9)
    ds_write_b128 v29, v[68:71] offset:0
    ds_write_b128 v29, v[72:75] offset:2048
    s_mov_b32 s52, 1327104
    buffer_store_dwordx4 v[144:147], v9, s[36:39], s52 offen sc1
    ds_write_b128 v29, v[76:79] offset:4096
    ds_write_b128 v29, v[80:83] offset:6144
    s_mov_b32 s52, 1474560
    buffer_store_dwordx4 v[148:151], v9, s[36:39], s52 offen sc1
    ds_write_b128 v29, v[84:87] offset:8192
    ds_write_b128 v29, v[88:91] offset:10240
    s_waitcnt lgkmcnt(7)
    s_mov_b32 s52, 1622016
    buffer_store_dwordx4 v[152:155], v9, s[36:39], s52 offen sc1
    ds_write_b128 v29, v[92:95] offset:12288
    ds_write_b128 v29, v[96:99] offset:14336
    s_waitcnt lgkmcnt(8)
    s_mov_b32 s52, 1769472
    buffer_store_dwordx4 v[156:159], v9, s[36:39], s52 offen sc1
    ds_write_b128 v29, v[100:103] offset:16384
    s_waitcnt lgkmcnt(0)
    s_barrier
    ds_read_b128 v[160:163], v8 offset:24576
    ds_read_b128 v[164:167], v8 offset:28672
    s_waitcnt lgkmcnt(1)
    s_mov_b32 s52, 1916928
    buffer_store_dwordx4 v[160:163], v9, s[36:39], s52 offen sc1
    s_waitcnt lgkmcnt(0)
    s_mov_b32 s52, 2064384
    buffer_store_dwordx4 v[164:167], v9, s[36:39], s52 offen sc1
    s_barrier
    ds_read_b128 v[168:171], v8 offset:16384
    ds_read_b128 v[172:175], v8 offset:20480
    s_waitcnt lgkmcnt(1)
    s_mov_b32 s52, 2211840
    buffer_store_dwordx4 v[168:171], v9, s[36:39], s52 offen sc1
    s_waitcnt lgkmcnt(0)
    s_mov_b32 s52, 2359296
    buffer_store_dwordx4 v[172:175], v9, s[36:39], s52 offen sc1
    s_endpgm
L_compute:
    v_lshrrev_b32 v13, 3, v0
    s_and_b32 s50, s3, 1
    s_lshl_b32 s55, s50, 10
    s_lshl_b32 s50, s50, 2
    v_lshrrev_b32 v14, 1, v13
    v_add_u32 v14, s50, v14
    v_and_b32 v15, 7, v0
    v_xor_b32 v14, v14, v15
    s_lshl_b32 s50, s3, 3
    v_add_u32 v13, s50, v13
    v_mul_u32_u24 v7, 1152, v13
    v_lshl_add_u32 v7, v14, 4, v7
    s_lshl_b32 s53, s3, 10
    s_lshr_b32 s50, s3, 1
    s_mul_i32 s50, s50, 18432
    s_add_u32 s55, s55, s50
    s_sub_u32 s95, 0, s50
    s_add_u32 s81, s80, 128
    s_cmp_eq_u32 s81, 1152
    s_cselect_b32 s81, 0, s81
    s_add_u32 s82, s81, 128
    s_cmp_eq_u32 s82, 1152
    s_cselect_b32 s82, 0, s82
    s_add_u32 s83, s82, 128
    s_cmp_eq_u32 s83, 1152
    s_cselect_b32 s83, 0, s83
    s_add_u32 s84, s83, 128
    s_cmp_eq_u32 s84, 1152
    s_cselect_b32 s84, 0, s84
    s_add_u32 s85, s84, 128
    s_cmp_eq_u32 s85, 1152
    s_cselect_b32 s85, 0, s85
    s_add_u32 s86, s85, 128
    s_cmp_eq_u32 s86, 1152
    s_cselect_b32 s86, 0, s86
    s_add_u32 s87, s86, 128
    s_cmp_eq_u32 s87, 1152
    s_cselect_b32 s87, 0, s87
    s_add_u32 s88, s87, 128
    s_cmp_eq_u32 s88, 1152
    s_cselect_b32 s88, 0, s88
    s_waitcnt lgkmcnt(0)
    s_add_u32 s16, s4, s46
    s_addc_u32 s17, s5, 0
    s_and_b32 s17, s17, 0xffff
    s_sub_u32 s18, 2359296, s46
    s_mov_b32 s19, 0x20000
    s_cmp_lg_u32 s3, 0
    s_cbranch_scc1 L_sk4
    s_mov_b32 m0, 69632
    s_add_u32 s52, s80, 331776
    buffer_load_dwordx4 v7, s[16:19], s52 offen lds
L_sk4:
    s_add_u32 m0, s53, 49152
    s_add_u32 s52, s80, 0
    buffer_load_dwordx4 v7, s[16:19], s52 offen lds
    s_add_u32 m0, s53, 53248
    s_add_u32 s52, s80, 36864
    buffer_load_dwordx4 v7, s[16:19], s52 offen lds
    s_add_u32 m0, s53, 57344
    s_add_u32 s52, s80, 73728
    buffer_load_dwordx4 v7, s[16:19], s52 offen lds
    s_add_u32 m0, s53, 61440
    s_add_u32 s52, s80, 110592
    buffer_load_dwordx4 v7, s[16:19], s52 offen lds
    s_add_u32 m0, s53, 65536
    s_add_u32 s52, s80, 147456
    buffer_load_dwordx4 v7, s[16:19], s52 offen lds
    v_and_b32 v10, 15, v0
    v_lshrrev_b32 v11, 4, v0
    v_lshrrev_b32 v12, 1, v10
    v_xor_b32 v12, v12, v11
    v_lshlrev_b32 v2, 7, v10
    v_lshl_add_u32 v2, v12, 4, v2
    v_add_u32 v2, 49152, v2
    v_xor_b32 v3, 64, v2
    v_and_b32 v12, 2, v10
    v_lshlrev_b32 v12, 2, v12
    v_lshrrev_b32 v13, 2, v10
    v_lshl_add_u32 v12, v13, 1, v12
    v_and_b32 v13, 1, v10
    v_add_u32 v12, v12, v13
    v_lshl_add_u32 v12, v11, 4, v12
    s_lshl_b32 s50, s3, 12
    v_lshlrev_b32 v4, 4, v12
    v_add_u32 v4, s50, v4
    v_xor_b32 v5, 16, v4
    s_lshl_b32 s50, s3, 2
    v_add_u32 v12, s50, v11
    v_and_b32 v13, 7, v10
    v_xor_b32 v12, v12, v13
    v_lshlrev_b32 v6, 8, v10
    v_lshl_add_u32 v6, v12, 4, v6
    v_mul_u32_u24 v1, 9216, v10
    v_lshl_add_u32 v1, v11, 4, v1
    s_lshl_b32 s50, s3, 6
    v_add_u32 v1, s50, v1
    s_add_u32 s36, s14, s48
    s_addc_u32 s37, s15, 0
    s_and_b32 s37, s37, 0xffff
    s_sub_u32 s38, 18874368, s48
    s_mov_b32 s39, 0x20000
    v_mov_b32 v8, 0
    v_mov_b32 v9, 0
    v_mov_b32 v10, 0
    v_mov_b32 v11, 0
    s_mul_i32 s50, s3, 22528
    s_cmp_eq_u32 s3, 3
    s_cselect_b32 s50, 0, s50
    s_add_u32 s50, s50, 70656
    v_lshlrev_b32 v12, 4, v0
    v_add_u32 v12, s50, v12
    ds_write_b128 v12, v[8:11]
    s_waitcnt lgkmcnt(0)
    s_mov_b32 s90, 0x00ff00ff
    s_mov_b32 s91, 0x00ff00ff
    s_waitcnt vmcnt(0)
    s_cmp_lg_u32 s3, 0
    s_cbranch_scc1 L_sk5
    s_mov_b32 m0, 92160
    s_add_u32 s52, s81, 331776
    buffer_load_dwordx4 v7, s[16:19], s52 offen lds
L_sk5:
    s_add_u32 m0, s53, 71680
    s_add_u32 s52, s81, 0
    buffer_load_dwordx4 v7, s[16:19], s52 offen lds
    s_add_u32 m0, s53, 75776
    s_add_u32 s52, s81, 36864
    buffer_load_dwordx4 v7, s[16:19], s52 offen lds
    s_add_u32 m0, s53, 79872
    s_add_u32 s52, s81, 73728
    buffer_load_dwordx4 v7, s[16:19], s52 offen lds
    s_add_u32 m0, s53, 83968
    s_add_u32 s52, s81, 110592
    buffer_load_dwordx4 v7, s[16:19], s52 offen lds
    s_add_u32 m0, s53, 88064
    s_add_u32 s52, s81, 147456
    buffer_load_dwordx4 v7, s[16:19], s52 offen lds
    s_barrier
    ds_read_b128 v[112:115], v4 offset:0
    ds_read_b128 v[116:119], v5 offset:1024
    ds_read_b128 v[8:11], v2 offset:0
    ds_read_b128 v[120:123], v4 offset:2048
    ds_read_b128 v[124:127], v5 offset:3072
    ds_read_b128 v[12:15], v2 offset:2048
    ds_read_b128 v[16:19], v2 offset:4096
    ds_read_b128 v[20:23], v2 offset:6144
    ds_read_b128 v[240:243], v2 offset:8192
    ds_read_b128 v[244:247], v2 offset:20480
    s_waitcnt lgkmcnt(4)
    v_mfma_f32_16x16x32_bf16 v[24:27], v[112:115], v[8:11], 0
    v_mfma_f32_16x16x32_bf16 v[28:31], v[116:119], v[8:11], 0
    v_mfma_f32_16x16x32_bf16 v[36:39], v[116:119], v[12:15], 0
    ds_read_b128 v[248:251], v2 offset:10240
    v_mfma_f32_16x16x32_bf16 v[32:35], v[112:115], v[12:15], 0
    s_cmp_lg_u32 s3, 0
    s_cbranch_scc1 L_sk6
    s_mov_b32 m0, 114688
    s_add_u32 s52, s82, 331776
    buffer_load_dwordx4 v7, s[16:19], s52 offen lds
L_sk6:
    s_waitcnt lgkmcnt(3)
    v_mfma_f32_16x16x32_bf16 v[40:43], v[112:115], v[16:19], 0
    ds_read_b128 v[252:255], v2 offset:12288
    v_mfma_f32_16x16x32_bf16 v[44:47], v[116:119], v[16:19], 0
    v_mfma_f32_16x16x32_bf16 v[52:55], v[116:119], v[20:23], 0
    ds_read_b128 v[8:11], v2 offset:14336
    v_mfma_f32_16x16x32_bf16 v[48:51], v[112:115], v[20:23], 0
    s_waitcnt lgkmcnt(3)
    v_mfma_f32_16x16x32_bf16 v[56:59], v[112:115], v[240:243], 0
    ds_read_b128 v[12:15], v2 offset:16384
    v_mfma_f32_16x16x32_bf16 v[60:63], v[116:119], v[240:243], 0
    s_add_u32 m0, s53, 94208
    s_add_u32 s52, s82, 0
    buffer_load_dwordx4 v7, s[16:19], s52 offen lds
    v_mfma_f32_16x16x32_bf16 v[108:111], v[116:119], v[244:247], 0
    ds_read_b128 v[16:19], v2 offset:18432
    v_mfma_f32_16x16x32_bf16 v[104:107], v[112:115], v[244:247], 0
    s_waitcnt lgkmcnt(3)
    v_mfma_f32_16x16x32_bf16 v[64:67], v[112:115], v[248:251], 0
    ds_read_b128 v[20:23], v3 offset:0
    v_mfma_f32_16x16x32_bf16 v[68:71], v[116:119], v[248:251], 0
    v_mfma_f32_16x16x32_bf16 v[76:79], v[116:119], v[252:255], 0
    ds_read_b128 v[240:243], v3 offset:2048
    v_mfma_f32_16x16x32_bf16 v[72:75], v[112:115], v[252:255], 0
    s_add_u32 m0, s53, 98304
    s_add_u32 s52, s82, 36864
    buffer_load_dwordx4 v7, s[16:19], s52 offen lds
    s_waitcnt lgkmcnt(3)
    v_mfma_f32_16x16x32_bf16 v[80:83], v[112:115], v[8:11], 0
    ds_read_b128 v[244:247], v3 offset:4096
    v_mfma_f32_16x16x32_bf16 v[84:87], v[116:119], v[8:11], 0
    v_mfma_f32_16x16x32_bf16 v[92:95], v[116:119], v[12:15], 0
    ds_read_b128 v[248:251], v3 offset:6144
    v_mfma_f32_16x16x32_bf16 v[88:91], v[112:115], v[12:15], 0
    s_waitcnt lgkmcnt(3)
    v_mfma_f32_16x16x32_bf16 v[96:99], v[112:115], v[16:19], 0
    ds_read_b128 v[252:255], v3 offset:8192
    v_mfma_f32_16x16x32_bf16 v[100:103], v[116:119], v[16:19], 0
    s_add_u32 m0, s53, 102400
    s_add_u32 s52, s82, 73728
    buffer_load_dwordx4 v7, s[16:19], s52 offen lds
    v_mfma_f32_16x16x32_bf16 v[28:31], v[124:127], v[20:23], v[28:31]
    ds_read_b128 v[8:11], v3 offset:20480
    v_mfma_f32_16x16x32_bf16 v[24:27], v[120:123], v[20:23], v[24:27]
    s_waitcnt lgkmcnt(3)
    v_mfma_f32_16x16x32_bf16 v[32:35], v[120:123], v[240:243], v[32:35]
    ds_read_b128 v[12:15], v3 offset:10240
    v_mfma_f32_16x16x32_bf16 v[36:39], v[124:127], v[240:243], v[36:39]
    v_mfma_f32_16x16x32_bf16 v[44:47], v[124:127], v[244:247], v[44:47]
    ds_read_b128 v[16:19], v3 offset:12288
    v_mfma_f32_16x16x32_bf16 v[40:43], v[120:123], v[244:247], v[40:43]
    s_add_u32 m0, s53, 106496
    s_add_u32 s52, s82, 110592
    buffer_load_dwordx4 v7, s[16:19], s52 offen lds
    s_waitcnt lgkmcnt(3)
    v_mfma_f32_16x16x32_bf16 v[48:51], v[120:123], v[248:251], v[48:51]
    ds_read_b128 v[20:23], v3 offset:14336
    v_mfma_f32_16x16x32_bf16 v[52:55], v[124:127], v[248:251], v[52:55]
    v_mfma_f32_16x16x32_bf16 v[60:63], v[124:127], v[252:255], v[60:63]
    ds_read_b128 v[240:243], v3 offset:16384
    v_mfma_f32_16x16x32_bf16 v[56:59], v[120:123], v[252:255], v[56:59]
    s_waitcnt lgkmcnt(3)
    v_mfma_f32_16x16x32_bf16 v[104:107], v[120:123], v[8:11], v[104:107]
    ds_read_b128 v[244:247], v3 offset:18432
    v_mfma_f32_16x16x32_bf16 v[108:111], v[124:127], v[8:11], v[108:111]
    s_add_u32 m0, s53, 110592
    s_add_u32 s52, s82, 147456
    buffer_load_dwordx4 v7, s[16:19], s52 offen lds
    v_mfma_f32_16x16x32_bf16 v[68:71], v[124:127], v[12:15], v[68:71]
    v_mfma_f32_16x16x32_bf16 v[64:67], v[120:123], v[12:15], v[64:67]
    s_waitcnt lgkmcnt(2)
    v_mfma_f32_16x16x32_bf16 v[72:75], v[120:123], v[16:19], v[72:75]
    v_mfma_f32_16x16x32_bf16 v[76:79], v[124:127], v[16:19], v[76:79]
    s_waitcnt lgkmcnt(0)
    v_add_u32 v2, 22528, v2
    v_add_u32 v3, 22528, v3
    s_waitcnt vmcnt(5)
    s_barrier
    ds_read_b128 v[128:131], v4 offset:16384
    ds_read_b128 v[132:135], v5 offset:17408
    ds_read_b128 v[248:251], v2 offset:0
    v_mfma_f32_16x16x32_bf16 v[80:83], v[120:123], v[20:23], v[80:83]
    ds_read_b128 v[136:139], v4 offset:18432
    v_mfma_f32_16x16x32_bf16 v[84:87], v[124:127], v[20:23], v[84:87]
    ds_read_b128 v[140:143], v5 offset:19456
    v_mfma_f32_16x16x32_bf16 v[88:91], v[120:123], v[240:243], v[88:91]
    ds_read_b128 v[252:255], v2 offset:2048
    v_mfma_f32_16x16x32_bf16 v[92:95], v[124:127], v[240:243], v[92:95]
    ds_read_b128 v[8:11], v2 offset:4096
    v_mfma_f32_16x16x32_bf16 v[96:99], v[120:123], v[244:247], v[96:99]
    ds_read_b128 v[12:15], v2 offset:6144
    v_mfma_f32_16x16x32_bf16 v[100:103], v[124:127], v[244:247], v[100:103]
    ds_read_b128 v[16:19], v2 offset:8192
    ds_read_b128 v[20:23], v2 offset:20480
    s_waitcnt lgkmcnt(4)
    v_mfma_f32_16x16x32_bf16 v[24:27], v[128:131], v[248:251], v[24:27]
    v_mfma_f32_16x16x32_bf16 v[28:31], v[132:135], v[248:251], v[28:31]
    v_mfma_f32_16x16x32_bf16 v[36:39], v[132:135], v[252:255], v[36:39]
    ds_read_b128 v[240:243], v2 offset:10240
    v_mfma_f32_16x16x32_bf16 v[32:35], v[128:131], v[252:255], v[32:35]
    s_cmp_lg_u32 s3, 0
    s_cbranch_scc1 L_sk7
    s_mov_b32 m0, 69632
    s_add_u32 s52, s83, 331776
    buffer_load_dwordx4 v7, s[16:19], s52 offen lds
L_sk7:
    s_waitcnt lgkmcnt(3)
    v_mfma_f32_16x16x32_bf16 v[40:43], v[128:131], v[8:11], v[40:43]
    ds_read_b128 v[244:247], v2 offset:12288
    v_mfma_f32_16x16x32_bf16 v[44:47], v[132:135], v[8:11], v[44:47]
    v_mfma_f32_16x16x32_bf16 v[52:55], v[132:135], v[12:15], v[52:55]
    ds_read_b128 v[248:251], v2 offset:14336
    v_mfma_f32_16x16x32_bf16 v[48:51], v[128:131], v[12:15], v[48:51]
    s_waitcnt lgkmcnt(3)
    v_mfma_f32_16x16x32_bf16 v[56:59], v[128:131], v[16:19], v[56:59]
    ds_read_b128 v[252:255], v2 offset:16384
    v_mfma_f32_16x16x32_bf16 v[60:63], v[132:135], v[16:19], v[60:63]
    s_add_u32 m0, s53, 49152
    s_add_u32 s52, s83, 0
    buffer_load_dwordx4 v7, s[16:19], s52 offen lds
    v_mfma_f32_16x16x32_bf16 v[108:111], v[132:135], v[20:23], v[108:111]
    ds_read_b128 v[8:11], v2 offset:18432
    v_mfma_f32_16x16x32_bf16 v[104:107], v[128:131], v[20:23], v[104:107]
    s_waitcnt lgkmcnt(3)
    v_mfma_f32_16x16x32_bf16 v[64:67], v[128:131], v[240:243], v[64:67]
    ds_read_b128 v[12:15], v3 offset:0
    v_mfma_f32_16x16x32_bf16 v[68:71], v[132:135], v[240:243], v[68:71]
    v_mfma_f32_16x16x32_bf16 v[76:79], v[132:135], v[244:247], v[76:79]
    ds_read_b128 v[16:19], v3 offset:2048
    v_mfma_f32_16x16x32_bf16 v[72:75], v[128:131], v[244:247], v[72:75]
    s_add_u32 m0, s53, 53248
    s_add_u32 s52, s83, 36864
    buffer_load_dwordx4 v7, s[16:19], s52 offen lds
    s_waitcnt lgkmcnt(3)
    v_mfma_f32_16x16x32_bf16 v[80:83], v[128:131], v[248:251], v[80:83]
    ds_read_b128 v[20:23], v3 offset:4096
    v_mfma_f32_16x16x32_bf16 v[84:87], v[132:135], v[248:251], v[84:87]
    v_mfma_f32_16x16x32_bf16 v[92:95], v[132:135], v[252:255], v[92:95]
    ds_read_b128 v[240:243], v3 offset:6144
    v_mfma_f32_16x16x32_bf16 v[88:91], v[128:131], v[252:255], v[88:91]
    s_waitcnt lgkmcnt(3)
    v_mfma_f32_16x16x32_bf16 v[96:99], v[128:131], v[8:11], v[96:99]
    ds_read_b128 v[244:247], v3 offset:8192
    v_mfma_f32_16x16x32_bf16 v[100:103], v[132:135], v[8:11], v[100:103]
    s_add_u32 m0, s53, 57344
    s_add_u32 s52, s83, 73728
    buffer_load_dwordx4 v7, s[16:19], s52 offen lds
    v_mfma_f32_16x16x32_bf16 v[28:31], v[140:143], v[12:15], v[28:31]
    ds_read_b128 v[248:251], v3 offset:20480
    v_mfma_f32_16x16x32_bf16 v[24:27], v[136:139], v[12:15], v[24:27]
    s_waitcnt lgkmcnt(3)
    v_mfma_f32_16x16x32_bf16 v[32:35], v[136:139], v[16:19], v[32:35]
    ds_read_b128 v[252:255], v3 offset:10240
    v_mfma_f32_16x16x32_bf16 v[36:39], v[140:143], v[16:19], v[36:39]
    v_mfma_f32_16x16x32_bf16 v[44:47], v[140:143], v[20:23], v[44:47]
    ds_read_b128 v[8:11], v3 offset:12288
    v_mfma_f32_16x16x32_bf16 v[40:43], v[136:139], v[20:23], v[40:43]
    s_add_u32 m0, s53, 61440
    s_add_u32 s52, s83, 110592
    buffer_load_dwordx4 v7, s[16:19], s52 offen lds
    s_waitcnt lgkmcnt(3)
    v_mfma_f32_16x16x32_bf16 v[48:51], v[136:139], v[240:243], v[48:51]
    ds_read_b128 v[12:15], v3 offset:14336
    v_mfma_f32_16x16x32_bf16 v[52:55], v[140:143], v[240:243], v[52:55]
    v_mfma_f32_16x16x32_bf16 v[60:63], v[140:143], v[244:247], v[60:63]
    ds_read_b128 v[16:19], v3 offset:16384
    v_mfma_f32_16x16x32_bf16 v[56:59], v[136:139], v[244:247], v[56:59]
    s_waitcnt lgkmcnt(3)
    v_mfma_f32_16x16x32_bf16 v[104:107], v[136:139], v[248:251], v[104:107]
    ds_read_b128 v[20:23], v3 offset:18432
    v_mfma_f32_16x16x32_bf16 v[108:111], v[140:143], v[248:251], v[108:111]
    s_add_u32 m0, s53, 65536
    s_add_u32 s52, s83, 147456
    buffer_load_dwordx4 v7, s[16:19], s52 offen lds
    v_mfma_f32_16x16x32_bf16 v[68:71], v[140:143], v[252:255], v[68:71]
    v_mfma_f32_16x16x32_bf16 v[64:67], v[136:139], v[252:255], v[64:67]
    s_waitcnt lgkmcnt(2)
    v_mfma_f32_16x16x32_bf16 v[72:75], v[136:139], v[8:11], v[72:75]
    v_mfma_f32_16x16x32_bf16 v[76:79], v[140:143], v[8:11], v[76:79]
    s_waitcnt lgkmcnt(0)
    v_add_u32 v2, 22528, v2
    v_add_u32 v3, 22528, v3
    s_waitcnt vmcnt(5)
    s_barrier
    ds_read_b128 v[144:147], v4 offset:0
    ds_read_b128 v[148:151], v5 offset:1024
    ds_read_b128 v[240:243], v2 offset:0
    v_mfma_f32_16x16x32_bf16 v[80:83], v[136:139], v[12:15], v[80:83]
    ds_read_b128 v[152:155], v4 offset:2048
    v_mfma_f32_16x16x32_bf16 v[84:87], v[140:143], v[12:15], v[84:87]
    ds_read_b128 v[156:159], v5 offset:3072
    v_mfma_f32_16x16x32_bf16 v[88:91], v[136:139], v[16:19], v[88:91]
    ds_read_b128 v[244:247], v2 offset:2048
    v_mfma_f32_16x16x32_bf16 v[92:95], v[140:143], v[16:19], v[92:95]
    ds_read_b128 v[248:251], v2 offset:4096
    v_mfma_f32_16x16x32_bf16 v[96:99], v[136:139], v[20:23], v[96:99]
    ds_read_b128 v[252:255], v2 offset:6144
    v_mfma_f32_16x16x32_bf16 v[100:103], v[140:143], v[20:23], v[100:103]
    ds_read_b128 v[8:11], v2 offset:8192
    ds_read_b128 v[12:15], v2 offset:20480
    s_waitcnt lgkmcnt(4)
    v_mfma_f32_16x16x32_bf16 v[24:27], v[144:147], v[240:243], v[24:27]
    v_mfma_f32_16x16x32_bf16 v[28:31], v[148:151], v[240:243], v[28:31]
    v_mfma_f32_16x16x32_bf16 v[36:39], v[148:151], v[244:247], v[36:39]
    ds_read_b128 v[16:19], v2 offset:10240
    v_mfma_f32_16x16x32_bf16 v[32:35], v[144:147], v[244:247], v[32:35]
    s_cmp_lg_u32 s3, 0
    s_cbranch_scc1 L_sk8
    s_mov_b32 m0, 92160
    s_add_u32 s52, s84, 331776
    buffer_load_dwordx4 v7, s[16:19], s52 offen lds
L_sk8:
    s_waitcnt lgkmcnt(3)
    v_mfma_f32_16x16x32_bf16 v[40:43], v[144:147], v[248:251], v[40:43]
    ds_read_b128 v[20:23], v2 offset:12288
    v_mfma_f32_16x16x32_bf16 v[44:47], v[148:151], v[248:251], v[44:47]
    v_mfma_f32_16x16x32_bf16 v[52:55], v[148:151], v[252:255], v[52:55]
    ds_read_b128 v[240:243], v2 offset:14336
    v_mfma_f32_16x16x32_bf16 v[48:51], v[144:147], v[252:255], v[48:51]
    s_waitcnt lgkmcnt(3)
    v_mfma_f32_16x16x32_bf16 v[56:59], v[144:147], v[8:11], v[56:59]
    ds_read_b128 v[244:247], v2 offset:16384
    v_mfma_f32_16x16x32_bf16 v[60:63], v[148:151], v[8:11], v[60:63]
    s_add_u32 m0, s53, 71680
    s_add_u32 s52, s84, 0
    buffer_load_dwordx4 v7, s[16:19], s52 offen lds
    v_mfma_f32_16x16x32_bf16 v[108:111], v[148:151], v[12:15], v[108:111]
    ds_read_b128 v[248:251], v2 offset:18432
    v_mfma_f32_16x16x32_bf16 v[104:107], v[144:147], v[12:15], v[104:107]
    s_waitcnt lgkmcnt(3)
    v_mfma_f32_16x16x32_bf16 v[64:67], v[144:147], v[16:19], v[64:67]
    ds_read_b128 v[252:255], v3 offset:0
    v_mfma_f32_16x16x32_bf16 v[68:71], v[148:151], v[16:19], v[68:71]
    v_mfma_f32_16x16x32_bf16 v[76:79], v[148:151], v[20:23], v[76:79]
    ds_read_b128 v[8:11], v3 offset:2048
    v_mfma_f32_16x16x32_bf16 v[72:75], v[144:147], v[20:23], v[72:75]
    s_add_u32 m0, s53, 75776
    s_add_u32 s52, s84, 36864
    buffer_load_dwordx4 v7, s[16:19], s52 offen lds
    s_waitcnt lgkmcnt(3)
    v_mfma_f32_16x16x32_bf16 v[80:83], v[144:147], v[240:243], v[80:83]
    ds_read_b128 v[12:15], v3 offset:4096
    v_mfma_f32_16x16x32_bf16 v[84:87], v[148:151], v[240:243], v[84:87]
    v_mfma_f32_16x16x32_bf16 v[92:95], v[148:151], v[244:247], v[92:95]
    ds_read_b128 v[16:19], v3 offset:6144
    v_mfma_f32_16x16x32_bf16 v[88:91], v[144:147], v[244:247], v[88:91]
    s_waitcnt lgkmcnt(3)
    v_mfma_f32_16x16x32_bf16 v[96:99], v[144:147], v[248:251], v[96:99]
    ds_read_b128 v[20:23], v3 offset:8192
    v_mfma_f32_16x16x32_bf16 v[100:103], v[148:151], v[248:251], v[100:103]
    s_add_u32 m0, s53, 79872
    s_add_u32 s52, s84, 73728
    buffer_load_dwordx4 v7, s[16:19], s52 offen lds
    v_mfma_f32_16x16x32_bf16 v[28:31], v[156:159], v[252:255], v[28:31]
    ds_read_b128 v[240:243], v3 offset:20480
    v_mfma_f32_16x16x32_bf16 v[24:27], v[152:155], v[252:255], v[24:27]
    s_waitcnt lgkmcnt(3)
    v_mfma_f32_16x16x32_bf16 v[32:35], v[152:155], v[8:11], v[32:35]
    ds_read_b128 v[244:247], v3 offset:10240
    v_mfma_f32_16x16x32_bf16 v[36:39], v[156:159], v[8:11], v[36:39]
    v_mfma_f32_16x16x32_bf16 v[44:47], v[156:159], v[12:15], v[44:47]
    ds_read_b128 v[248:251], v3 offset:12288
    v_mfma_f32_16x16x32_bf16 v[40:43], v[152:155], v[12:15], v[40:43]
    s_add_u32 m0, s53, 83968
    s_add_u32 s52, s84, 110592
    buffer_load_dwordx4 v7, s[16:19], s52 offen lds
    s_waitcnt lgkmcnt(3)
    v_mfma_f32_16x16x32_bf16 v[48:51], v[152:155], v[16:19], v[48:51]
    ds_read_b128 v[252:255], v3 offset:14336
    v_mfma_f32_16x16x32_bf16 v[52:55], v[156:159], v[16:19], v[52:55]
    v_mfma_f32_16x16x32_bf16 v[60:63], v[156:159], v[20:23], v[60:63]
    ds_read_b128 v[8:11], v3 offset:16384
    v_mfma_f32_16x16x32_bf16 v[56:59], v[152:155], v[20:23], v[56:59]
    s_waitcnt lgkmcnt(3)
    v_mfma_f32_16x16x32_bf16 v[104:107], v[152:155], v[240:243], v[104:107]
    ds_read_b128 v[12:15], v3 offset:18432
    v_mfma_f32_16x16x32_bf16 v[108:111], v[156:159], v[240:243], v[108:111]
    s_add_u32 m0, s53, 88064
    s_add_u32 s52, s84, 147456
    buffer_load_dwordx4 v7, s[16:19], s52 offen lds
    v_mfma_f32_16x16x32_bf16 v[68:71], v[156:159], v[244:247], v[68:71]
    v_mfma_f32_16x16x32_bf16 v[64:67], v[152:155], v[244:247], v[64:67]
    s_waitcnt lgkmcnt(2)
    v_mfma_f32_16x16x32_bf16 v[72:75], v[152:155], v[248:251], v[72:75]
    v_mfma_f32_16x16x32_bf16 v[76:79], v[156:159], v[248:251], v[76:79]
    s_waitcnt lgkmcnt(0)
    v_subrev_u32 v2, 45056, v2
    v_subrev_u32 v3, 45056, v3
    s_waitcnt vmcnt(5)
    s_barrier
    ds_read_b128 v[160:163], v4 offset:16384
    ds_read_b128 v[164:167], v5 offset:17408
    ds_read_b128 v[16:19], v2 offset:0
    v_mfma_f32_16x16x32_bf16 v[80:83], v[152:155], v[252:255], v[80:83]
    ds_read_b128 v[168:171], v4 offset:18432
    v_mfma_f32_16x16x32_bf16 v[84:87], v[156:159], v[252:255], v[84:87]
    ds_read_b128 v[172:175], v5 offset:19456
    v_mfma_f32_16x16x32_bf16 v[88:91], v[152:155], v[8:11], v[88:91]
    ds_read_b128 v[20:23], v2 offset:2048
    v_mfma_f32_16x16x32_bf16 v[92:95], v[156:159], v[8:11], v[92:95]
    ds_read_b128 v[240:243], v2 offset:4096
    v_mfma_f32_16x16x32_bf16 v[96:99], v[152:155], v[12:15], v[96:99]
    ds_read_b128 v[244:247], v2 offset:6144
    v_mfma_f32_16x16x32_bf16 v[100:103], v[156:159], v[12:15], v[100:103]
    ds_read_b128 v[248:251], v2 offset:8192
    ds_read_b128 v[252:255], v2 offset:20480
    s_waitcnt lgkmcnt(4)
    v_mfma_f32_16x16x32_bf16 v[24:27], v[160:163], v[16:19], v[24:27]
    v_mfma_f32_16x16x32_bf16 v[28:31], v[164:167], v[16:19], v[28:31]
    v_mfma_f32_16x16x32_bf16 v[36:39], v[164:167], v[20:23], v[36:39]
    ds_read_b128 v[8:11], v2 offset:10240
    v_mfma_f32_16x16x32_bf16 v[32:35], v[160:163], v[20:23], v[32:35]
    s_cmp_lg_u32 s3, 0
    s_cbranch_scc1 L_sk9
    s_mov_b32 m0, 114688
    s_add_u32 s52, s85, 331776
    buffer_load_dwordx4 v7, s[16:19], s52 offen lds
L_sk9:
    s_waitcnt lgkmcnt(3)
    v_mfma_f32_16x16x32_bf16 v[40:43], v[160:163], v[240:243], v[40:43]
    ds_read_b128 v[12:15], v2 offset:12288
    v_mfma_f32_16x16x32_bf16 v[44:47], v[164:167], v[240:243], v[44:47]
    v_mfma_f32_16x16x32_bf16 v[52:55], v[164:167], v[244:247], v[52:55]
    ds_read_b128 v[16:19], v2 offset:14336
    v_mfma_f32_16x16x32_bf16 v[48:51], v[160:163], v[244:247], v[48:51]
    s_waitcnt lgkmcnt(3)
    v_mfma_f32_16x16x32_bf16 v[56:59], v[160:163], v[248:251], v[56:59]
    ds_read_b128 v[20:23], v2 offset:16384
    v_mfma_f32_16x16x32_bf16 v[60:63], v[164:167], v[248:251], v[60:63]
    s_add_u32 m0, s53, 94208
    s_add_u32 s52, s85, 0
    buffer_load_dwordx4 v7, s[16:19], s52 offen lds
    v_mfma_f32_16x16x32_bf16 v[108:111], v[164:167], v[252:255], v[108:111]
    ds_read_b128 v[240:243], v2 offset:18432
    v_mfma_f32_16x16x32_bf16 v[104:107], v[160:163], v[252:255], v[104:107]
    s_waitcnt lgkmcnt(3)
    v_mfma_f32_16x16x32_bf16 v[64:67], v[160:163], v[8:11], v[64:67]
    ds_read_b128 v[244:247], v3 offset:0
    v_mfma_f32_16x16x32_bf16 v[68:71], v[164:167], v[8:11], v[68:71]
    v_mfma_f32_16x16x32_bf16 v[76:79], v[164:167], v[12:15], v[76:79]
    ds_read_b128 v[248:251], v3 offset:2048
    v_mfma_f32_16x16x32_bf16 v[72:75], v[160:163], v[12:15], v[72:75]
    s_add_u32 m0, s53, 98304
    s_add_u32 s52, s85, 36864
    buffer_load_dwordx4 v7, s[16:19], s52 offen lds
    s_waitcnt lgkmcnt(3)
    v_mfma_f32_16x16x32_bf16 v[80:83], v[160:163], v[16:19], v[80:83]
    ds_read_b128 v[252:255], v3 offset:4096
    v_mfma_f32_16x16x32_bf16 v[84:87], v[164:167], v[16:19], v[84:87]
    v_mfma_f32_16x16x32_bf16 v[92:95], v[164:167], v[20:23], v[92:95]
    ds_read_b128 v[8:11], v3 offset:6144
    v_mfma_f32_16x16x32_bf16 v[88:91], v[160:163], v[20:23], v[88:91]
    s_waitcnt lgkmcnt(3)
    v_mfma_f32_16x16x32_bf16 v[96:99], v[160:163], v[240:243], v[96:99]
    ds_read_b128 v[12:15], v3 offset:8192
    v_mfma_f32_16x16x32_bf16 v[100:103], v[164:167], v[240:243], v[100:103]
    s_add_u32 m0, s53, 102400
    s_add_u32 s52, s85, 73728
    buffer_load_dwordx4 v7, s[16:19], s52 offen lds
    v_mfma_f32_16x16x32_bf16 v[28:31], v[172:175], v[244:247], v[28:31]
    ds_read_b128 v[16:19], v3 offset:20480
    v_mfma_f32_16x16x32_bf16 v[24:27], v[168:171], v[244:247], v[24:27]
    s_waitcnt lgkmcnt(3)
    v_mfma_f32_16x16x32_bf16 v[32:35], v[168:171], v[248:251], v[32:35]
    ds_read_b128 v[20:23], v3 offset:10240
    v_mfma_f32_16x16x32_bf16 v[36:39], v[172:175], v[248:251], v[36:39]
    v_mfma_f32_16x16x32_bf16 v[44:47], v[172:175], v[252:255], v[44:47]
    ds_read_b128 v[240:243], v3 offset:12288
    v_mfma_f32_16x16x32_bf16 v[40:43], v[168:171], v[252:255], v[40:43]
    s_add_u32 m0, s53, 106496
    s_add_u32 s52, s85, 110592
    buffer_load_dwordx4 v7, s[16:19], s52 offen lds
    s_waitcnt lgkmcnt(3)
    v_mfma_f32_16x16x32_bf16 v[48:51], v[168:171], v[8:11], v[48:51]
    ds_read_b128 v[244:247], v3 offset:14336
    v_mfma_f32_16x16x32_bf16 v[52:55], v[172:175], v[8:11], v[52:55]
    v_mfma_f32_16x16x32_bf16 v[60:63], v[172:175], v[12:15], v[60:63]
    ds_read_b128 v[248:251], v3 offset:16384
    v_mfma_f32_16x16x32_bf16 v[56:59], v[168:171], v[12:15], v[56:59]
    s_waitcnt lgkmcnt(3)
    v_mfma_f32_16x16x32_bf16 v[104:107], v[168:171], v[16:19], v[104:107]
    ds_read_b128 v[252:255], v3 offset:18432
    v_mfma_f32_16x16x32_bf16 v[108:111], v[172:175], v[16:19], v[108:111]
    s_add_u32 m0, s53, 110592
    s_add_u32 s52, s85, 147456
    buffer_load_dwordx4 v7, s[16:19], s52 offen lds
    v_mfma_f32_16x16x32_bf16 v[68:71], v[172:175], v[20:23], v[68:71]
    v_mfma_f32_16x16x32_bf16 v[64:67], v[168:171], v[20:23], v[64:67]
    s_waitcnt lgkmcnt(2)
    v_mfma_f32_16x16x32_bf16 v[72:75], v[168:171], v[240:243], v[72:75]
    v_mfma_f32_16x16x32_bf16 v[76:79], v[172:175], v[240:243], v[76:79]
    s_waitcnt lgkmcnt(0)
    v_add_u32 v2, 22528, v2
    v_add_u32 v3, 22528, v3
    s_waitcnt vmcnt(5)
    s_barrier
    ds_read_b128 v[176:179], v4 offset:0
    ds_read_b128 v[180:183], v5 offset:1024
    ds_read_b128 v[8:11], v2 offset:0
    v_mfma_f32_16x16x32_bf16 v[80:83], v[168:171], v[244:247], v[80:83]
    ds_read_b128 v[184:187], v4 offset:2048
    v_mfma_f32_16x16x32_bf16 v[84:87], v[172:175], v[244:247], v[84:87]
    ds_read_b128 v[188:191], v5 offset:3072
    v_mfma_f32_16x16x32_bf16 v[88:91], v[168:171], v[248:251], v[88:91]
    ds_read_b128 v[12:15], v2 offset:2048
    v_mfma_f32_16x16x32_bf16 v[92:95], v[172:175], v[248:251], v[92:95]
    ds_read_b128 v[16:19], v2 offset:4096
    v_mfma_f32_16x16x32_bf16 v[96:99], v[168:171], v[252:255], v[96:99]
    ds_read_b128 v[20:23], v2 offset:6144
    v_mfma_f32_16x16x32_bf16 v[100:103], v[172:175], v[252:255], v[100:103]
    ds_read_b128 v[240:243], v2 offset:8192
    ds_read_b128 v[244:247], v2 offset:20480
    s_waitcnt lgkmcnt(4)
    v_mfma_f32_16x16x32_bf16 v[24:27], v[176:179], v[8:11], v[24:27]
    v_mfma_f32_16x16x32_bf16 v[28:31], v[180:183], v[8:11], v[28:31]
    v_mfma_f32_16x16x32_bf16 v[36:39], v[180:183], v[12:15], v[36:39]
    ds_read_b128 v[248:251], v2 offset:10240
    v_mfma_f32_16x16x32_bf16 v[32:35], v[176:179], v[12:15], v[32:35]
    s_cmp_lg_u32 s3, 0
    s_cbranch_scc1 L_sk10
    s_mov_b32 m0, 69632
    s_add_u32 s52, s86, 331776
    buffer_load_dwordx4 v7, s[16:19], s52 offen lds
L_sk10:
    s_waitcnt lgkmcnt(3)
    v_mfma_f32_16x16x32_bf16 v[40:43], v[176:179], v[16:19], v[40:43]
    ds_read_b128 v[252:255], v2 offset:12288
    v_mfma_f32_16x16x32_bf16 v[44:47], v[180:183], v[16:19], v[44:47]
    v_mfma_f32_16x16x32_bf16 v[52:55], v[180:183], v[20:23], v[52:55]
    ds_read_b128 v[8:11], v2 offset:14336
    v_mfma_f32_16x16x32_bf16 v[48:51], v[176:179], v[20:23], v[48:51]
    s_waitcnt lgkmcnt(3)
    v_mfma_f32_16x16x32_bf16 v[56:59], v[176:179], v[240:243], v[56:59]
    ds_read_b128 v[12:15], v2 offset:16384
    v_mfma_f32_16x16x32_bf16 v[60:63], v[180:183], v[240:243], v[60:63]
    s_add_u32 m0, s53, 49152
    s_add_u32 s52, s86, 0
    buffer_load_dwordx4 v7, s[16:19], s52 offen lds
    v_mfma_f32_16x16x32_bf16 v[108:111], v[180:183], v[244:247], v[108:111]
    ds_read_b128 v[16:19], v2 offset:18432
    v_mfma_f32_16x16x32_bf16 v[104:107], v[176:179], v[244:247], v[104:107]
    s_waitcnt lgkmcnt(3)
    v_mfma_f32_16x16x32_bf16 v[64:67], v[176:179], v[248:251], v[64:67]
    ds_read_b128 v[20:23], v3 offset:0
    v_mfma_f32_16x16x32_bf16 v[68:71], v[180:183], v[248:251], v[68:71]
    v_mfma_f32_16x16x32_bf16 v[76:79], v[180:183], v[252:255], v[76:79]
    ds_read_b128 v[240:243], v3 offset:2048
    v_mfma_f32_16x16x32_bf16 v[72:75], v[176:179], v[252:255], v[72:75]
    s_add_u32 m0, s53, 53248
    s_add_u32 s52, s86, 36864
    buffer_load_dwordx4 v7, s[16:19], s52 offen lds
    s_waitcnt lgkmcnt(3)
    v_mfma_f32_16x16x32_bf16 v[80:83], v[176:179], v[8:11], v[80:83]
    ds_read_b128 v[244:247], v3 offset:4096
    v_mfma_f32_16x16x32_bf16 v[84:87], v[180:183], v[8:11], v[84:87]
    v_mfma_f32_16x16x32_bf16 v[92:95], v[180:183], v[12:15], v[92:95]
    ds_read_b128 v[248:251], v3 offset:6144
    v_mfma_f32_16x16x32_bf16 v[88:91], v[176:179], v[12:15], v[88:91]
    s_waitcnt lgkmcnt(3)
    v_mfma_f32_16x16x32_bf16 v[96:99], v[176:179], v[16:19], v[96:99]
    ds_read_b128 v[252:255], v3 offset:8192
    v_mfma_f32_16x16x32_bf16 v[100:103], v[180:183], v[16:19], v[100:103]
    s_add_u32 m0, s53, 57344
    s_add_u32 s52, s86, 73728
    buffer_load_dwordx4 v7, s[16:19], s52 offen lds
    v_mfma_f32_16x16x32_bf16 v[28:31], v[188:191], v[20:23], v[28:31]
    ds_read_b128 v[8:11], v3 offset:20480
    v_mfma_f32_16x16x32_bf16 v[24:27], v[184:187], v[20:23], v[24:27]
    s_waitcnt lgkmcnt(3)
    v_mfma_f32_16x16x32_bf16 v[32:35], v[184:187], v[240:243], v[32:35]
    ds_read_b128 v[12:15], v3 offset:10240
    v_mfma_f32_16x16x32_bf16 v[36:39], v[188:191], v[240:243], v[36:39]
    v_mfma_f32_16x16x32_bf16 v[44:47], v[188:191], v[244:247], v[44:47]
    ds_read_b128 v[16:19], v3 offset:12288
    v_mfma_f32_16x16x32_bf16 v[40:43], v[184:187], v[244:247], v[40:43]
    s_add_u32 m0, s53, 61440
    s_add_u32 s52, s86, 110592
    buffer_load_dwordx4 v7, s[16:19], s52 offen lds
    s_waitcnt lgkmcnt(3)
    v_mfma_f32_16x16x32_bf16 v[48:51], v[184:187], v[248:251], v[48:51]
    ds_read_b128 v[20:23], v3 offset:14336
    v_mfma_f32_16x16x32_bf16 v[52:55], v[188:191], v[248:251], v[52:55]
    v_mfma_f32_16x16x32_bf16 v[60:63], v[188:191], v[252:255], v[60:63]
    ds_read_b128 v[240:243], v3 offset:16384
    v_mfma_f32_16x16x32_bf16 v[56:59], v[184:187], v[252:255], v[56:59]
    s_waitcnt lgkmcnt(3)
    v_mfma_f32_16x16x32_bf16 v[104:107], v[184:187], v[8:11], v[104:107]
    ds_read_b128 v[244:247], v3 offset:18432
    v_mfma_f32_16x16x32_bf16 v[108:111], v[188:191], v[8:11], v[108:111]
    s_add_u32 m0, s53, 65536
    s_add_u32 s52, s86, 147456
    buffer_load_dwordx4 v7, s[16:19], s52 offen lds
    v_mfma_f32_16x16x32_bf16 v[68:71], v[188:191], v[12:15], v[68:71]
    v_mfma_f32_16x16x32_bf16 v[64:67], v[184:187], v[12:15], v[64:67]
    s_waitcnt lgkmcnt(2)
    v_mfma_f32_16x16x32_bf16 v[72:75], v[184:187], v[16:19], v[72:75]
    v_mfma_f32_16x16x32_bf16 v[76:79], v[188:191], v[16:19], v[76:79]
    s_waitcnt lgkmcnt(0)
    v_add_u32 v2, 22528, v2
    v_add_u32 v3, 22528, v3
    s_waitcnt vmcnt(5)
    s_barrier
    ds_read_b128 v[192:195], v4 offset:16384
    ds_read_b128 v[196:199], v5 offset:17408
    ds_read_b128 v[248:251], v2 offset:0
    v_mfma_f32_16x16x32_bf16 v[80:83], v[184:187], v[20:23], v[80:83]
    ds_read_b128 v[200:203], v4 offset:18432
    v_mfma_f32_16x16x32_bf16 v[84:87], v[188:191], v[20:23], v[84:87]
    ds_read_b128 v[204:207], v5 offset:19456
    v_mfma_f32_16x16x32_bf16 v[88:91], v[184:187], v[240:243], v[88:91]
    ds_read_b128 v[252:255], v2 offset:2048
    v_mfma_f32_16x16x32_bf16 v[92:95], v[188:191], v[240:243], v[92:95]
    ds_read_b128 v[8:11], v2 offset:4096
    v_mfma_f32_16x16x32_bf16 v[96:99], v[184:187], v[244:247], v[96:99]
    ds_read_b128 v[12:15], v2 offset:6144
    v_mfma_f32_16x16x32_bf16 v[100:103], v[188:191], v[244:247], v[100:103]
    ds_read_b128 v[16:19], v2 offset:8192
    ds_read_b128 v[20:23], v2 offset:20480
    s_waitcnt lgkmcnt(4)
    v_mfma_f32_16x16x32_bf16 v[24:27], v[192:195], v[248:251], v[24:27]
    v_mfma_f32_16x16x32_bf16 v[28:31], v[196:199], v[248:251], v[28:31]
    v_mfma_f32_16x16x32_bf16 v[36:39], v[196:199], v[252:255], v[36:39]
    ds_read_b128 v[240:243], v2 offset:10240
    v_mfma_f32_16x16x32_bf16 v[32:35], v[192:195], v[252:255], v[32:35]
    s_cmp_lg_u32 s3, 0
    s_cbranch_scc1 L_sk11
    s_mov_b32 m0, 92160
    s_add_u32 s52, s87, 331776
    buffer_load_dwordx4 v7, s[16:19], s52 offen lds
L_sk11:
    s_waitcnt lgkmcnt(3)
    v_mfma_f32_16x16x32_bf16 v[40:43], v[192:195], v[8:11], v[40:43]
    ds_read_b128 v[244:247], v2 offset:12288
    v_mfma_f32_16x16x32_bf16 v[44:47], v[196:199], v[8:11], v[44:47]
    v_mfma_f32_16x16x32_bf16 v[52:55], v[196:199], v[12:15], v[52:55]
    ds_read_b128 v[248:251], v2 offset:14336
    v_mfma_f32_16x16x32_bf16 v[48:51], v[192:195], v[12:15], v[48:51]
    s_waitcnt lgkmcnt(3)
    v_mfma_f32_16x16x32_bf16 v[56:59], v[192:195], v[16:19], v[56:59]
    ds_read_b128 v[252:255], v2 offset:16384
    v_mfma_f32_16x16x32_bf16 v[60:63], v[196:199], v[16:19], v[60:63]
    s_add_u32 m0, s53, 71680
    s_add_u32 s52, s87, 0
    buffer_load_dwordx4 v7, s[16:19], s52 offen lds
    v_mfma_f32_16x16x32_bf16 v[108:111], v[196:199], v[20:23], v[108:111]
    ds_read_b128 v[8:11], v2 offset:18432
    v_mfma_f32_16x16x32_bf16 v[104:107], v[192:195], v[20:23], v[104:107]
    s_waitcnt lgkmcnt(3)
    v_mfma_f32_16x16x32_bf16 v[64:67], v[192:195], v[240:243], v[64:67]
    ds_read_b128 v[12:15], v3 offset:0
    v_mfma_f32_16x16x32_bf16 v[68:71], v[196:199], v[240:243], v[68:71]
    v_mfma_f32_16x16x32_bf16 v[76:79], v[196:199], v[244:247], v[76:79]
    ds_read_b128 v[16:19], v3 offset:2048
    v_mfma_f32_16x16x32_bf16 v[72:75], v[192:195], v[244:247], v[72:75]
    s_add_u32 m0, s53, 75776
    s_add_u32 s52, s87, 36864
    buffer_load_dwordx4 v7, s[16:19], s52 offen lds
    s_waitcnt lgkmcnt(3)
    v_mfma_f32_16x16x32_bf16 v[80:83], v[192:195], v[248:251], v[80:83]
    ds_read_b128 v[20:23], v3 offset:4096
    v_mfma_f32_16x16x32_bf16 v[84:87], v[196:199], v[248:251], v[84:87]
    v_mfma_f32_16x16x32_bf16 v[92:95], v[196:199], v[252:255], v[92:95]
    ds_read_b128 v[240:243], v3 offset:6144
    v_mfma_f32_16x16x32_bf16 v[88:91], v[192:195], v[252:255], v[88:91]
    s_waitcnt lgkmcnt(3)
    v_mfma_f32_16x16x32_bf16 v[96:99], v[192:195], v[8:11], v[96:99]
    ds_read_b128 v[244:247], v3 offset:8192
    v_mfma_f32_16x16x32_bf16 v[100:103], v[196:199], v[8:11], v[100:103]
    s_add_u32 m0, s53, 79872
    s_add_u32 s52, s87, 73728
    buffer_load_dwordx4 v7, s[16:19], s52 offen lds
    v_mfma_f32_16x16x32_bf16 v[28:31], v[204:207], v[12:15], v[28:31]
    ds_read_b128 v[248:251], v3 offset:20480
    v_mfma_f32_16x16x32_bf16 v[24:27], v[200:203], v[12:15], v[24:27]
    s_waitcnt lgkmcnt(3)
    v_mfma_f32_16x16x32_bf16 v[32:35], v[200:203], v[16:19], v[32:35]
    ds_read_b128 v[252:255], v3 offset:10240
    v_mfma_f32_16x16x32_bf16 v[36:39], v[204:207], v[16:19], v[36:39]
    v_mfma_f32_16x16x32_bf16 v[44:47], v[204:207], v[20:23], v[44:47]
    ds_read_b128 v[8:11], v3 offset:12288
    v_mfma_f32_16x16x32_bf16 v[40:43], v[200:203], v[20:23], v[40:43]
    s_add_u32 m0, s53, 83968
    s_add_u32 s52, s87, 110592
    buffer_load_dwordx4 v7, s[16:19], s52 offen lds
    s_waitcnt lgkmcnt(3)
    v_mfma_f32_16x16x32_bf16 v[48:51], v[200:203], v[240:243], v[48:51]
    ds_read_b128 v[12:15], v3 offset:14336
    v_mfma_f32_16x16x32_bf16 v[52:55], v[204:207], v[240:243], v[52:55]
    v_mfma_f32_16x16x32_bf16 v[60:63], v[204:207], v[244:247], v[60:63]
    ds_read_b128 v[16:19], v3 offset:16384
    v_mfma_f32_16x16x32_bf16 v[56:59], v[200:203], v[244:247], v[56:59]
    s_waitcnt lgkmcnt(3)
    v_mfma_f32_16x16x32_bf16 v[104:107], v[200:203], v[248:251], v[104:107]
    ds_read_b128 v[20:23], v3 offset:18432
    v_mfma_f32_16x16x32_bf16 v[108:111], v[204:207], v[248:251], v[108:111]
    s_add_u32 m0, s53, 88064
    s_add_u32 s52, s87, 147456
    buffer_load_dwordx4 v7, s[16:19], s52 offen lds
    v_mfma_f32_16x16x32_bf16 v[68:71], v[204:207], v[252:255], v[68:71]
    v_mfma_f32_16x16x32_bf16 v[64:67], v[200:203], v[252:255], v[64:67]
    s_waitcnt lgkmcnt(2)
    v_mfma_f32_16x16x32_bf16 v[72:75], v[200:203], v[8:11], v[72:75]
    v_mfma_f32_16x16x32_bf16 v[76:79], v[204:207], v[8:11], v[76:79]
    s_waitcnt lgkmcnt(0)
    v_subrev_u32 v2, 45056, v2
    v_subrev_u32 v3, 45056, v3
    s_waitcnt vmcnt(5)
    s_barrier
    ds_read_b128 v[208:211], v4 offset:0
    ds_read_b128 v[212:215], v5 offset:1024
    ds_read_b128 v[240:243], v2 offset:0
    v_mfma_f32_16x16x32_bf16 v[80:83], v[200:203], v[12:15], v[80:83]
    ds_read_b128 v[216:219], v4 offset:2048
    v_mfma_f32_16x16x32_bf16 v[84:87], v[204:207], v[12:15], v[84:87]
    ds_read_b128 v[220:223], v5 offset:3072
    v_mfma_f32_16x16x32_bf16 v[88:91], v[200:203], v[16:19], v[88:91]
    ds_read_b128 v[244:247], v2 offset:2048
    v_mfma_f32_16x16x32_bf16 v[92:95], v[204:207], v[16:19], v[92:95]
    ds_read_b128 v[248:251], v2 offset:4096
    v_mfma_f32_16x16x32_bf16 v[96:99], v[200:203], v[20:23], v[96:99]
    ds_read_b128 v[252:255], v2 offset:6144
    v_mfma_f32_16x16x32_bf16 v[100:103], v[204:207], v[20:23], v[100:103]
    ds_read_b128 v[8:11], v2 offset:8192
    ds_read_b128 v[12:15], v2 offset:20480
    s_waitcnt lgkmcnt(4)
    v_mfma_f32_16x16x32_bf16 v[24:27], v[208:211], v[240:243], v[24:27]
    v_mfma_f32_16x16x32_bf16 v[28:31], v[212:215], v[240:243], v[28:31]
    v_mfma_f32_16x16x32_bf16 v[36:39], v[212:215], v[244:247], v[36:39]
    ds_read_b128 v[16:19], v2 offset:10240
    v_mfma_f32_16x16x32_bf16 v[32:35], v[208:211], v[244:247], v[32:35]
    s_cmp_lg_u32 s3, 0
    s_cbranch_scc1 L_sk12
    s_mov_b32 m0, 114688
    s_add_u32 s52, s88, 331776
    buffer_load_dwordx4 v7, s[16:19], s52 offen lds
L_sk12:
    s_waitcnt lgkmcnt(3)
    v_mfma_f32_16x16x32_bf16 v[40:43], v[208:211], v[248:251], v[40:43]
    ds_read_b128 v[20:23], v2 offset:12288
    v_mfma_f32_16x16x32_bf16 v[44:47], v[212:215], v[248:251], v[44:47]
    v_mfma_f32_16x16x32_bf16 v[52:55], v[212:215], v[252:255], v[52:55]
    ds_read_b128 v[240:243], v2 offset:14336
    v_mfma_f32_16x16x32_bf16 v[48:51], v[208:211], v[252:255], v[48:51]
    s_waitcnt lgkmcnt(3)
    v_mfma_f32_16x16x32_bf16 v[56:59], v[208:211], v[8:11], v[56:59]
    ds_read_b128 v[244:247], v2 offset:16384
    v_mfma_f32_16x16x32_bf16 v[60:63], v[212:215], v[8:11], v[60:63]
    s_add_u32 m0, s53, 94208
    s_add_u32 s52, s88, 0
    buffer_load_dwordx4 v7, s[16:19], s52 offen lds
    v_mfma_f32_16x16x32_bf16 v[108:111], v[212:215], v[12:15], v[108:111]
    ds_read_b128 v[248:251], v2 offset:18432
    v_mfma_f32_16x16x32_bf16 v[104:107], v[208:211], v[12:15], v[104:107]
    s_waitcnt lgkmcnt(3)
    v_mfma_f32_16x16x32_bf16 v[64:67], v[208:211], v[16:19], v[64:67]
    ds_read_b128 v[252:255], v3 offset:0
    v_mfma_f32_16x16x32_bf16 v[68:71], v[212:215], v[16:19], v[68:71]
    v_mfma_f32_16x16x32_bf16 v[76:79], v[212:215], v[20:23], v[76:79]
    ds_read_b128 v[8:11], v3 offset:2048
    v_mfma_f32_16x16x32_bf16 v[72:75], v[208:211], v[20:23], v[72:75]
    s_add_u32 m0, s53, 98304
    s_add_u32 s52, s88, 36864
    buffer_load_dwordx4 v7, s[16:19], s52 offen lds
    s_waitcnt lgkmcnt(3)
    v_mfma_f32_16x16x32_bf16 v[80:83], v[208:211], v[240:243], v[80:83]
    ds_read_b128 v[12:15], v3 offset:4096
    v_mfma_f32_16x16x32_bf16 v[84:87], v[212:215], v[240:243], v[84:87]
    v_mfma_f32_16x16x32_bf16 v[92:95], v[212:215], v[244:247], v[92:95]
    ds_read_b128 v[16:19], v3 offset:6144
    v_mfma_f32_16x16x32_bf16 v[88:91], v[208:211], v[244:247], v[88:91]
    s_waitcnt lgkmcnt(3)
    v_mfma_f32_16x16x32_bf16 v[96:99], v[208:211], v[248:251], v[96:99]
    ds_read_b128 v[20:23], v3 offset:8192
    v_mfma_f32_16x16x32_bf16 v[100:103], v[212:215], v[248:251], v[100:103]
    s_add_u32 m0, s53, 102400
    s_add_u32 s52, s88, 73728
    buffer_load_dwordx4 v7, s[16:19], s52 offen lds
    v_mfma_f32_16x16x32_bf16 v[28:31], v[220:223], v[252:255], v[28:31]
    ds_read_b128 v[240:243], v3 offset:20480
    v_mfma_f32_16x16x32_bf16 v[24:27], v[216:219], v[252:255], v[24:27]
    s_waitcnt lgkmcnt(3)
    v_mfma_f32_16x16x32_bf16 v[32:35], v[216:219], v[8:11], v[32:35]
    ds_read_b128 v[244:247], v3 offset:10240
    v_mfma_f32_16x16x32_bf16 v[36:39], v[220:223], v[8:11], v[36:39]
    v_mfma_f32_16x16x32_bf16 v[44:47], v[220:223], v[12:15], v[44:47]
    ds_read_b128 v[248:251], v3 offset:12288
    v_mfma_f32_16x16x32_bf16 v[40:43], v[216:219], v[12:15], v[40:43]
    s_add_u32 m0, s53, 106496
    s_add_u32 s52, s88, 110592
    buffer_load_dwordx4 v7, s[16:19], s52 offen lds
    s_waitcnt lgkmcnt(3)
    v_mfma_f32_16x16x32_bf16 v[48:51], v[216:219], v[16:19], v[48:51]
    ds_read_b128 v[252:255], v3 offset:14336
    v_mfma_f32_16x16x32_bf16 v[52:55], v[220:223], v[16:19], v[52:55]
    v_mfma_f32_16x16x32_bf16 v[60:63], v[220:223], v[20:23], v[60:63]
    ds_read_b128 v[8:11], v3 offset:16384
    v_mfma_f32_16x16x32_bf16 v[56:59], v[216:219], v[20:23], v[56:59]
    s_waitcnt lgkmcnt(3)
    v_mfma_f32_16x16x32_bf16 v[104:107], v[216:219], v[240:243], v[104:107]
    ds_read_b128 v[12:15], v3 offset:18432
    v_mfma_f32_16x16x32_bf16 v[108:111], v[220:223], v[240:243], v[108:111]
    s_add_u32 m0, s53, 110592
    s_add_u32 s52, s88, 147456
    buffer_load_dwordx4 v7, s[16:19], s52 offen lds
    v_mfma_f32_16x16x32_bf16 v[68:71], v[220:223], v[244:247], v[68:71]
    v_mfma_f32_16x16x32_bf16 v[64:67], v[216:219], v[244:247], v[64:67]
    s_waitcnt lgkmcnt(2)
    v_mfma_f32_16x16x32_bf16 v[72:75], v[216:219], v[248:251], v[72:75]
    v_mfma_f32_16x16x32_bf16 v[76:79], v[220:223], v[248:251], v[76:79]
    s_waitcnt lgkmcnt(0)
    v_add_u32 v2, 22528, v2
    v_add_u32 v3, 22528, v3
    s_waitcnt vmcnt(5)
    s_barrier
    ds_read_b128 v[224:227], v4 offset:16384
    ds_read_b128 v[228:231], v5 offset:17408
    ds_read_b128 v[16:19], v2 offset:0
    v_mfma_f32_16x16x32_bf16 v[80:83], v[216:219], v[252:255], v[80:83]
    ds_read_b128 v[232:235], v4 offset:18432
    v_mfma_f32_16x16x32_bf16 v[84:87], v[220:223], v[252:255], v[84:87]
    ds_read_b128 v[236:239], v5 offset:19456
    v_mfma_f32_16x16x32_bf16 v[88:91], v[216:219], v[8:11], v[88:91]
    ds_read_b128 v[20:23], v2 offset:2048
    v_mfma_f32_16x16x32_bf16 v[92:95], v[220:223], v[8:11], v[92:95]
    ds_read_b128 v[240:243], v2 offset:4096
    v_mfma_f32_16x16x32_bf16 v[96:99], v[216:219], v[12:15], v[96:99]
    ds_read_b128 v[244:247], v2 offset:6144
    v_mfma_f32_16x16x32_bf16 v[100:103], v[220:223], v[12:15], v[100:103]
    ds_read_b128 v[248:251], v2 offset:8192
    ds_read_b128 v[252:255], v2 offset:20480
    s_waitcnt lgkmcnt(4)
    v_mfma_f32_16x16x32_bf16 v[24:27], v[224:227], v[16:19], v[24:27]
    v_mfma_f32_16x16x32_bf16 v[28:31], v[228:231], v[16:19], v[28:31]
    v_mfma_f32_16x16x32_bf16 v[36:39], v[228:231], v[20:23], v[36:39]
    ds_read_b128 v[8:11], v2 offset:10240
    v_mfma_f32_16x16x32_bf16 v[32:35], v[224:227], v[20:23], v[32:35]
    s_add_u32 m0, s55, 126976
    s_add_u32 s52, s80, 184320
    buffer_load_dwordx4 v7, s[16:19], s52 offen lds
    s_waitcnt lgkmcnt(3)
    v_mfma_f32_16x16x32_bf16 v[40:43], v[224:227], v[240:243], v[40:43]
    ds_read_b128 v[12:15], v2 offset:12288
    v_mfma_f32_16x16x32_bf16 v[44:47], v[228:231], v[240:243], v[44:47]
    v_mfma_f32_16x16x32_bf16 v[52:55], v[228:231], v[244:247], v[52:55]
    ds_read_b128 v[16:19], v2 offset:14336
    v_mfma_f32_16x16x32_bf16 v[48:51], v[224:227], v[244:247], v[48:51]
    s_waitcnt lgkmcnt(3)
    v_mfma_f32_16x16x32_bf16 v[56:59], v[224:227], v[248:251], v[56:59]
    ds_read_b128 v[20:23], v2 offset:16384
    v_mfma_f32_16x16x32_bf16 v[60:63], v[228:231], v[248:251], v[60:63]
    s_add_u32 m0, s55, 129024
    s_add_u32 s52, s81, 184320
    buffer_load_dwordx4 v7, s[16:19], s52 offen lds
    v_mfma_f32_16x16x32_bf16 v[108:111], v[228:231], v[252:255], v[108:111]
    ds_read_b128 v[240:243], v2 offset:18432
    v_mfma_f32_16x16x32_bf16 v[104:107], v[224:227], v[252:255], v[104:107]
    s_waitcnt lgkmcnt(3)
    v_mfma_f32_16x16x32_bf16 v[64:67], v[224:227], v[8:11], v[64:67]
    ds_read_b128 v[244:247], v3 offset:0
    v_mfma_f32_16x16x32_bf16 v[68:71], v[228:231], v[8:11], v[68:71]
    v_mfma_f32_16x16x32_bf16 v[76:79], v[228:231], v[12:15], v[76:79]
    ds_read_b128 v[248:251], v3 offset:2048
    v_mfma_f32_16x16x32_bf16 v[72:75], v[224:227], v[12:15], v[72:75]
    s_add_u32 m0, s55, 131072
    s_add_u32 s52, s82, 184320
    buffer_load_dwordx4 v7, s[16:19], s52 offen lds
    s_waitcnt lgkmcnt(3)
    v_mfma_f32_16x16x32_bf16 v[80:83], v[224:227], v[16:19], v[80:83]
    ds_read_b128 v[252:255], v3 offset:4096
    v_mfma_f32_16x16x32_bf16 v[84:87], v[228:231], v[16:19], v[84:87]
    v_mfma_f32_16x16x32_bf16 v[92:95], v[228:231], v[20:23], v[92:95]
    v_mfma_f32_16x16x32_bf16 v[88:91], v[224:227], v[20:23], v[88:91]
    s_waitcnt lgkmcnt(2)
    v_mfma_f32_16x16x32_bf16 v[96:99], v[224:227], v[240:243], v[96:99]
    v_mfma_f32_16x16x32_bf16 v[100:103], v[228:231], v[240:243], v[100:103]
    ds_read_b128 v[240:243], v3 offset:6144
    s_add_u32 m0, s55, 133120
    s_add_u32 s52, s83, 184320
    buffer_load_dwordx4 v7, s[16:19], s52 offen lds
    v_mfma_f32_16x16x32_bf16 v[28:31], v[236:239], v[244:247], v[28:31]
    v_mfma_f32_16x16x32_bf16 v[24:27], v[232:235], v[244:247], v[24:27]
    ds_read_b128 v[244:247], v3 offset:8192
    s_waitcnt lgkmcnt(2)
    v_mfma_f32_16x16x32_bf16 v[32:35], v[232:235], v[248:251], v[32:35]
    v_mfma_f32_16x16x32_bf16 v[36:39], v[236:239], v[248:251], v[36:39]
    ds_read_b128 v[248:251], v3 offset:20480
    v_mfma_f32_16x16x32_bf16 v[44:47], v[236:239], v[252:255], v[44:47]
    v_mfma_f32_16x16x32_bf16 v[40:43], v[232:235], v[252:255], v[40:43]
    ds_read_b128 v[252:255], v3 offset:10240
    s_add_u32 m0, s55, 135168
    s_add_u32 s52, s84, 184320
    buffer_load_dwordx4 v7, s[16:19], s52 offen lds
    s_waitcnt lgkmcnt(2)
    v_mfma_f32_16x16x32_bf16 v[48:51], v[232:235], v[240:243], v[48:51]
    ds_read_b128 v[8:11], v3 offset:12288
    v_mfma_f32_16x16x32_bf16 v[52:55], v[236:239], v[240:243], v[52:55]
    ds_read_b128 v[12:15], v3 offset:14336
    v_mfma_f32_16x16x32_bf16 v[60:63], v[236:239], v[244:247], v[60:63]
    ds_read_b128 v[16:19], v3 offset:16384
    v_mfma_f32_16x16x32_bf16 v[56:59], v[232:235], v[244:247], v[56:59]
    s_waitcnt lgkmcnt(3)
    v_mfma_f32_16x16x32_bf16 v[104:107], v[232:235], v[248:251], v[104:107]
    ds_read_b128 v[20:23], v3 offset:18432
    v_mfma_f32_16x16x32_bf16 v[108:111], v[236:239], v[248:251], v[108:111]
    s_add_u32 m0, s55, 137216
    s_add_u32 s52, s85, 184320
    buffer_load_dwordx4 v7, s[16:19], s52 offen lds
    v_mfma_f32_16x16x32_bf16 v[68:71], v[236:239], v[252:255], v[68:71]
    v_mfma_f32_16x16x32_bf16 v[64:67], v[232:235], v[252:255], v[64:67]
    s_waitcnt lgkmcnt(2)
    v_mfma_f32_16x16x32_bf16 v[72:75], v[232:235], v[8:11], v[72:75]
    v_mfma_f32_16x16x32_bf16 v[76:79], v[236:239], v[8:11], v[76:79]
    s_add_u32 m0, s55, 139264
    s_add_u32 s52, s86, 184320
    buffer_load_dwordx4 v7, s[16:19], s52 offen lds
    s_add_u32 m0, s55, 141312
    s_add_u32 s52, s87, 184320
    buffer_load_dwordx4 v7, s[16:19], s52 offen lds
    s_add_u32 m0, s55, 143360
    s_add_u32 s52, s88, 184320
    buffer_load_dwordx4 v7, s[16:19], s52 offen lds
    s_waitcnt lgkmcnt(0)
    v_add_u32 v2, 22528, v2
    v_add_u32 v3, 22528, v3
    s_waitcnt vmcnt(9)
    s_barrier
    ds_read_b128 v[240:243], v4 offset:0
    ds_read_b128 v[244:247], v5 offset:1024
    ds_read_b128 v[8:11], v2 offset:0
    v_mfma_f32_16x16x32_bf16 v[80:83], v[232:235], v[12:15], v[80:83]
    ds_read_b128 v[248:251], v4 offset:2048
    v_mfma_f32_16x16x32_bf16 v[84:87], v[236:239], v[12:15], v[84:87]
    ds_read_b128 v[252:255], v5 offset:3072
    v_mfma_f32_16x16x32_bf16 v[88:91], v[232:235], v[16:19], v[88:91]
    ds_read_b128 v[12:15], v3 offset:0
    v_mfma_f32_16x16x32_bf16 v[92:95], v[236:239], v[16:19], v[92:95]
    ds_read_b128 v[16:19], v2 offset:2048
    v_mfma_f32_16x16x32_bf16 v[96:99], v[232:235], v[20:23], v[96:99]
    v_mfma_f32_16x16x32_bf16 v[100:103], v[236:239], v[20:23], v[100:103]
    ds_read_b128 v[20:23], v3 offset:2048
    s_waitcnt lgkmcnt(5)
    v_mfma_f32_16x16x32_bf16 v[24:27], v[240:243], v[8:11], v[24:27]
    v_mfma_f32_16x16x32_bf16 v[28:31], v[244:247], v[8:11], v[28:31]
    s_waitcnt lgkmcnt(2)
    v_mfma_f32_16x16x32_bf16 v[24:27], v[248:251], v[12:15], v[24:27]
    ds_read_b128 v[8:11], v2 offset:4096
    v_mfma_f32_16x16x32_bf16 v[28:31], v[252:255], v[12:15], v[28:31]
    s_waitcnt lgkmcnt(2)
    v_mfma_f32_16x16x32_bf16 v[32:35], v[240:243], v[16:19], v[32:35]
    ds_read_b128 v[12:15], v3 offset:4096
    v_mfma_f32_16x16x32_bf16 v[36:39], v[244:247], v[16:19], v[36:39]
    s_waitcnt lgkmcnt(2)
    v_mfma_f32_16x16x32_bf16 v[32:35], v[248:251], v[20:23], v[32:35]
    ds_read_b128 v[16:19], v2 offset:6144
    v_mfma_f32_16x16x32_bf16 v[36:39], v[252:255], v[20:23], v[36:39]
    s_waitcnt lgkmcnt(2)
    v_mfma_f32_16x16x32_bf16 v[40:43], v[240:243], v[8:11], v[40:43]
    ds_read_b128 v[20:23], v3 offset:6144
    v_mfma_f32_16x16x32_bf16 v[44:47], v[244:247], v[8:11], v[44:47]
    s_waitcnt lgkmcnt(2)
    v_mfma_f32_16x16x32_bf16 v[40:43], v[248:251], v[12:15], v[40:43]
    ds_read_b128 v[8:11], v2 offset:8192
    v_mfma_f32_16x16x32_bf16 v[44:47], v[252:255], v[12:15], v[44:47]
    v_cvt_pk_bf16_f32 v24, v24, v25
    s_waitcnt lgkmcnt(2)
    v_mfma_f32_16x16x32_bf16 v[48:51], v[240:243], v[16:19], v[48:51]
    ds_read_b128 v[12:15], v3 offset:8192
    v_mfma_f32_16x16x32_bf16 v[52:55], v[244:247], v[16:19], v[52:55]
    v_cvt_pk_bf16_f32 v25, v26, v27
    s_waitcnt lgkmcnt(2)
    v_mfma_f32_16x16x32_bf16 v[48:51], v[248:251], v[20:23], v[48:51]
    ds_read_b128 v[16:19], v2 offset:20480
    v_mfma_f32_16x16x32_bf16 v[52:55], v[252:255], v[20:23], v[52:55]
    v_cvt_pk_bf16_f32 v26, v28, v29
    s_waitcnt lgkmcnt(2)
    v_mfma_f32_16x16x32_bf16 v[56:59], v[240:243], v[8:11], v[56:59]
    ds_read_b128 v[20:23], v3 offset:20480
    v_mfma_f32_16x16x32_bf16 v[60:63], v[244:247], v[8:11], v[60:63]
    v_cvt_pk_bf16_f32 v27, v30, v31
    s_waitcnt lgkmcnt(2)
    v_mfma_f32_16x16x32_bf16 v[56:59], v[248:251], v[12:15], v[56:59]
    ds_read_b128 v[8:11], v2 offset:10240
    v_mfma_f32_16x16x32_bf16 v[60:63], v[252:255], v[12:15], v[60:63]
    ds_write_b128 v6, v[24:27] offset:16384
    s_waitcnt lgkmcnt(3)
    v_mfma_f32_16x16x32_bf16 v[104:107], v[240:243], v[16:19], v[104:107]
    ds_read_b128 v[12:15], v3 offset:10240
    v_mfma_f32_16x16x32_bf16 v[108:111], v[244:247], v[16:19], v[108:111]
    v_cvt_pk_bf16_f32 v32, v32, v33
    s_waitcnt lgkmcnt(3)
    v_mfma_f32_16x16x32_bf16 v[104:107], v[248:251], v[20:23], v[104:107]
    ds_read_b128 v[16:19], v2 offset:12288
    v_mfma_f32_16x16x32_bf16 v[108:111], v[252:255], v[20:23], v[108:111]
    v_cvt_pk_bf16_f32 v33, v34, v35
    s_waitcnt lgkmcnt(3)
    v_mfma_f32_16x16x32_bf16 v[64:67], v[240:243], v[8:11], v[64:67]
    ds_read_b128 v[20:23], v3 offset:12288
    v_mfma_f32_16x16x32_bf16 v[68:71], v[244:247], v[8:11], v[68:71]
    v_cvt_pk_bf16_f32 v34, v36, v37
    s_waitcnt lgkmcnt(2)
    v_mfma_f32_16x16x32_bf16 v[64:67], v[248:251], v[12:15], v[64:67]
    ds_read_b128 v[8:11], v2 offset:14336
    v_mfma_f32_16x16x32_bf16 v[68:71], v[252:255], v[12:15], v[68:71]
    v_cvt_pk_bf16_f32 v35, v38, v39
    s_waitcnt lgkmcnt(2)
    v_mfma_f32_16x16x32_bf16 v[72:75], v[240:243], v[16:19], v[72:75]
    ds_read_b128 v[12:15], v3 offset:14336
    v_mfma_f32_16x16x32_bf16 v[76:79], v[244:247], v[16:19], v[76:79]
    ds_write_b128 v6, v[32:35] offset:20480
    s_waitcnt lgkmcnt(3)
    v_mfma_f32_16x16x32_bf16 v[72:75], v[248:251], v[20:23], v[72:75]
    ds_read_b128 v[16:19], v2 offset:16384
    v_mfma_f32_16x16x32_bf16 v[76:79], v[252:255], v[20:23], v[76:79]
    v_cvt_pk_bf16_f32 v40, v40, v41
    s_waitcnt lgkmcnt(3)
    v_mfma_f32_16x16x32_bf16 v[80:83], v[240:243], v[8:11], v[80:83]
    ds_read_b128 v[20:23], v3 offset:16384
    v_mfma_f32_16x16x32_bf16 v[84:87], v[244:247], v[8:11], v[84:87]
    v_cvt_pk_bf16_f32 v41, v42, v43
    s_waitcnt lgkmcnt(3)
    v_mfma_f32_16x16x32_bf16 v[80:83], v[248:251], v[12:15], v[80:83]
    ds_read_b128 v[8:11], v2 offset:18432
    v_mfma_f32_16x16x32_bf16 v[84:87], v[252:255], v[12:15], v[84:87]
    v_cvt_pk_bf16_f32 v42, v44, v45
    s_waitcnt lgkmcnt(2)
    v_mfma_f32_16x16x32_bf16 v[88:91], v[240:243], v[16:19], v[88:91]
    ds_read_b128 v[12:15], v3 offset:18432
    v_mfma_f32_16x16x32_bf16 v[92:95], v[244:247], v[16:19], v[92:95]
    v_cvt_pk_bf16_f32 v43, v46, v47
    ds_write_b128 v6, v[40:43] offset:24576
    s_waitcnt lgkmcnt(0)
    v_add_u32 v2, 32768, v2
    v_add_u32 v3, 32768, v3
    s_waitcnt vmcnt(0)
    s_barrier
    ds_read_b128 v[16:19], v2 offset:0
    ds_read_b128 v[40:43], v3 offset:0
    v_mfma_f32_16x16x32_bf16 v[88:91], v[248:251], v[20:23], v[88:91]
    ds_read_b128 v[44:47], v2 offset:2048
    v_mfma_f32_16x16x32_bf16 v[92:95], v[252:255], v[20:23], v[92:95]
    v_mfma_f32_16x16x32_bf16 v[96:99], v[240:243], v[8:11], v[96:99]
    v_mfma_f32_16x16x32_bf16 v[100:103], v[244:247], v[8:11], v[100:103]
    v_mfma_f32_16x16x32_bf16 v[96:99], v[248:251], v[12:15], v[96:99]
    v_mfma_f32_16x16x32_bf16 v[100:103], v[252:255], v[12:15], v[100:103]
    s_waitcnt lgkmcnt(1)
    v_mfma_f32_16x16x32_bf16 v[24:27], v[112:115], v[16:19], 0
    ds_read_b128 v[20:23], v3 offset:2048
    v_mfma_f32_16x16x32_bf16 v[28:31], v[116:119], v[16:19], 0
    ds_read_b128 v[8:11], v2 offset:4096
    v_mfma_f32_16x16x32_bf16 v[24:27], v[120:123], v[40:43], v[24:27]
    ds_read_b128 v[12:15], v3 offset:4096
    v_mfma_f32_16x16x32_bf16 v[28:31], v[124:127], v[40:43], v[28:31]
    ds_read_b128 v[16:19], v2 offset:6144
    v_cvt_pk_bf16_f32 v48, v48, v49
    v_cvt_pk_bf16_f32 v49, v50, v51
    s_waitcnt lgkmcnt(3)
    v_mfma_f32_16x16x32_bf16 v[24:27], v[128:131], v[44:47], v[24:27]
    ds_read_b128 v[40:43], v3 offset:6144
    v_mfma_f32_16x16x32_bf16 v[28:31], v[132:135], v[44:47], v[28:31]
    v_cvt_pk_bf16_f32 v50, v52, v53
    v_cvt_pk_bf16_f32 v51, v54, v55
    v_mfma_f32_16x16x32_bf16 v[24:27], v[136:139], v[20:23], v[24:27]
    ds_read_b128 v[44:47], v2 offset:8192
    v_mfma_f32_16x16x32_bf16 v[28:31], v[140:143], v[20:23], v[28:31]
    ds_write_b128 v6, v[48:51] offset:0
    v_cvt_pk_bf16_f32 v56, v56, v57
    s_waitcnt lgkmcnt(4)
    v_mfma_f32_16x16x32_bf16 v[24:27], v[144:147], v[8:11], v[24:27]
    ds_read_b128 v[20:23], v3 offset:8192
    v_mfma_f32_16x16x32_bf16 v[28:31], v[148:151], v[8:11], v[28:31]
    v_cvt_pk_bf16_f32 v57, v58, v59
    v_cvt_pk_bf16_f32 v58, v60, v61
    v_mfma_f32_16x16x32_bf16 v[24:27], v[152:155], v[12:15], v[24:27]
    ds_read_b128 v[8:11], v2 offset:10240
    v_mfma_f32_16x16x32_bf16 v[28:31], v[156:159], v[12:15], v[28:31]
    v_cvt_pk_bf16_f32 v59, v62, v63
    ds_write_b128 v6, v[56:59] offset:4096
    s_waitcnt lgkmcnt(5)
    v_mfma_f32_16x16x32_bf16 v[24:27], v[160:163], v[16:19], v[24:27]
    ds_read_b128 v[12:15], v3 offset:10240
    v_mfma_f32_16x16x32_bf16 v[28:31], v[164:167], v[16:19], v[28:31]
    v_cvt_pk_bf16_f32 v104, v104, v105
    v_cvt_pk_bf16_f32 v105, v106, v107
    v_mfma_f32_16x16x32_bf16 v[24:27], v[168:171], v[40:43], v[24:27]
    ds_read_b128 v[16:19], v2 offset:12288
    v_mfma_f32_16x16x32_bf16 v[28:31], v[172:175], v[40:43], v[28:31]
    v_cvt_pk_bf16_f32 v106, v108, v109
    v_cvt_pk_bf16_f32 v107, v110, v111
    s_waitcnt lgkmcnt(4)
    v_mfma_f32_16x16x32_bf16 v[24:27], v[176:179], v[44:47], v[24:27]
    ds_read_b128 v[40:43], v3 offset:12288
    v_mfma_f32_16x16x32_bf16 v[28:31], v[180:183], v[44:47], v[28:31]
    s_mov_b64 exec, s[90:91]
    ds_write_b128 v6, v[104:107] offset:8192
    s_mov_b64 exec, -1
    v_cvt_pk_bf16_f32 v64, v64, v65
    v_mfma_f32_16x16x32_bf16 v[24:27], v[184:187], v[20:23], v[24:27]
    ds_read_b128 v[44:47], v2 offset:14336
    v_mfma_f32_16x16x32_bf16 v[28:31], v[188:191], v[20:23], v[28:31]
    v_cvt_pk_bf16_f32 v65, v66, v67
    v_cvt_pk_bf16_f32 v66, v68, v69
    s_waitcnt lgkmcnt(4)
    v_mfma_f32_16x16x32_bf16 v[24:27], v[192:195], v[8:11], v[24:27]
    ds_read_b128 v[20:23], v3 offset:14336
    v_mfma_f32_16x16x32_bf16 v[28:31], v[196:199], v[8:11], v[28:31]
    v_cvt_pk_bf16_f32 v67, v70, v71
    ds_write_b128 v6, v[64:67] offset:12288
    v_mfma_f32_16x16x32_bf16 v[24:27], v[200:203], v[12:15], v[24:27]
    ds_read_b128 v[8:11], v2 offset:16384
    v_mfma_f32_16x16x32_bf16 v[28:31], v[204:207], v[12:15], v[28:31]
    v_cvt_pk_bf16_f32 v72, v72, v73
    v_cvt_pk_bf16_f32 v73, v74, v75
    s_waitcnt lgkmcnt(5)
    v_mfma_f32_16x16x32_bf16 v[24:27], v[208:211], v[16:19], v[24:27]
    ds_read_b128 v[12:15], v3 offset:16384
    v_mfma_f32_16x16x32_bf16 v[28:31], v[212:215], v[16:19], v[28:31]
    v_cvt_pk_bf16_f32 v74, v76, v77
    v_cvt_pk_bf16_f32 v75, v78, v79
    v_mfma_f32_16x16x32_bf16 v[24:27], v[216:219], v[40:43], v[24:27]
    ds_read_b128 v[16:19], v2 offset:18432
    v_mfma_f32_16x16x32_bf16 v[28:31], v[220:223], v[40:43], v[28:31]
    ds_write_b128 v6, v[72:75] offset:36864
    v_cvt_pk_bf16_f32 v80, v80, v81
    s_waitcnt lgkmcnt(5)
    v_mfma_f32_16x16x32_bf16 v[24:27], v[224:227], v[44:47], v[24:27]
    ds_read_b128 v[40:43], v3 offset:18432
    v_mfma_f32_16x16x32_bf16 v[28:31], v[228:231], v[44:47], v[28:31]
    v_cvt_pk_bf16_f32 v81, v82, v83
    v_cvt_pk_bf16_f32 v82, v84, v85
    v_mfma_f32_16x16x32_bf16 v[24:27], v[232:235], v[20:23], v[24:27]
    ds_read_b128 v[44:47], v2 offset:20480
    v_mfma_f32_16x16x32_bf16 v[28:31], v[236:239], v[20:23], v[28:31]
    v_cvt_pk_bf16_f32 v83, v86, v87
    s_waitcnt lgkmcnt(4)
    v_mfma_f32_16x16x32_bf16 v[24:27], v[240:243], v[8:11], v[24:27]
    ds_read_b128 v[20:23], v3 offset:20480
    v_mfma_f32_16x16x32_bf16 v[28:31], v[244:247], v[8:11], v[28:31]
    ds_write_b128 v6, v[80:83] offset:40960
    v_mfma_f32_16x16x32_bf16 v[24:27], v[248:251], v[12:15], v[24:27]
    ds_read_b128 v[8:11], v2 offset:22528
    v_mfma_f32_16x16x32_bf16 v[28:31], v[252:255], v[12:15], v[28:31]
    v_cvt_pk_bf16_f32 v88, v88, v89
    s_waitcnt lgkmcnt(4)
    v_mfma_f32_16x16x32_bf16 v[32:35], v[112:115], v[16:19], 0
    ds_read_b128 v[12:15], v3 offset:22528
    v_mfma_f32_16x16x32_bf16 v[36:39], v[116:119], v[16:19], 0
    v_cvt_pk_bf16_f32 v89, v90, v91
    v_mfma_f32_16x16x32_bf16 v[32:35], v[120:123], v[40:43], v[32:35]
    ds_read_b128 v[16:19], v2 offset:24576
    v_mfma_f32_16x16x32_bf16 v[36:39], v[124:127], v[40:43], v[36:39]
    v_cvt_pk_bf16_f32 v90, v92, v93
    s_waitcnt lgkmcnt(4)
    v_mfma_f32_16x16x32_bf16 v[32:35], v[128:131], v[44:47], v[32:35]
    ds_read_b128 v[40:43], v3 offset:24576
    v_mfma_f32_16x16x32_bf16 v[36:39], v[132:135], v[44:47], v[36:39]
    v_cvt_pk_bf16_f32 v91, v94, v95
    v_mfma_f32_16x16x32_bf16 v[32:35], v[136:139], v[20:23], v[32:35]
    ds_read_b128 v[44:47], v2 offset:26624
    v_mfma_f32_16x16x32_bf16 v[36:39], v[140:143], v[20:23], v[36:39]
    ds_write_b128 v6, v[88:91] offset:32768
    s_waitcnt lgkmcnt(4)
    v_mfma_f32_16x16x32_bf16 v[32:35], v[144:147], v[8:11], v[32:35]
    ds_read_b128 v[20:23], v3 offset:26624
    v_mfma_f32_16x16x32_bf16 v[36:39], v[148:151], v[8:11], v[36:39]
    v_cvt_pk_bf16_f32 v96, v96, v97
    v_mfma_f32_16x16x32_bf16 v[32:35], v[152:155], v[12:15], v[32:35]
    ds_read_b128 v[8:11], v2 offset:28672
    v_mfma_f32_16x16x32_bf16 v[36:39], v[156:159], v[12:15], v[36:39]
    v_cvt_pk_bf16_f32 v97, v98, v99
    s_waitcnt lgkmcnt(4)
    v_mfma_f32_16x16x32_bf16 v[32:35], v[160:163], v[16:19], v[32:35]
    ds_read_b128 v[12:15], v3 offset:28672
    v_mfma_f32_16x16x32_bf16 v[36:39], v[164:167], v[16:19], v[36:39]
    v_cvt_pk_bf16_f32 v98, v100, v101
    v_mfma_f32_16x16x32_bf16 v[32:35], v[168:171], v[40:43], v[32:35]
    ds_read_b128 v[16:19], v2 offset:30720
    v_mfma_f32_16x16x32_bf16 v[36:39], v[172:175], v[40:43], v[36:39]
    v_cvt_pk_bf16_f32 v99, v102, v103
    s_waitcnt lgkmcnt(3)
    v_mfma_f32_16x16x32_bf16 v[32:35], v[176:179], v[44:47], v[32:35]
    ds_read_b128 v[40:43], v3 offset:30720
    v_mfma_f32_16x16x32_bf16 v[36:39], v[180:183], v[44:47], v[36:39]
    ds_write_b128 v6, v[96:99] offset:28672
    v_mfma_f32_16x16x32_bf16 v[32:35], v[184:187], v[20:23], v[32:35]
    ds_read_b128 v[44:47], v2 offset:32768
    v_mfma_f32_16x16x32_bf16 v[36:39], v[188:191], v[20:23], v[36:39]
    v_cvt_pk_bf16_f32 v24, v24, v25
    s_waitcnt lgkmcnt(4)
    v_mfma_f32_16x16x32_bf16 v[32:35], v[192:195], v[8:11], v[32:35]
    ds_read_b128 v[20:23], v3 offset:32768
    v_mfma_f32_16x16x32_bf16 v[36:39], v[196:199], v[8:11], v[36:39]
    v_cvt_pk_bf16_f32 v25, v26, v27
    v_mfma_f32_16x16x32_bf16 v[32:35], v[200:203], v[12:15], v[32:35]
    ds_read_b128 v[8:11], v2 offset:34816
    v_mfma_f32_16x16x32_bf16 v[36:39], v[204:207], v[12:15], v[36:39]
    v_cvt_pk_bf16_f32 v26, v28, v29
    s_waitcnt lgkmcnt(4)
    v_mfma_f32_16x16x32_bf16 v[32:35], v[208:211], v[16:19], v[32:35]
    ds_read_b128 v[12:15], v3 offset:34816
    v_mfma_f32_16x16x32_bf16 v[36:39], v[212:215], v[16:19], v[36:39]
    v_cvt_pk_bf16_f32 v27, v30, v31
    v_mfma_f32_16x16x32_bf16 v[32:35], v[216:219], v[40:43], v[32:35]
    v_mfma_f32_16x16x32_bf16 v[36:39], v[220:223], v[40:43], v[36:39]
    ds_write_b128 v6, v[24:27] offset:45056
    s_waitcnt lgkmcnt(3)
    v_mfma_f32_16x16x32_bf16 v[32:35], v[224:227], v[44:47], v[32:35]
    v_mfma_f32_16x16x32_bf16 v[36:39], v[228:231], v[44:47], v[36:39]
    s_waitcnt lgkmcnt(0)
    s_mov_b32 s43, 4294889472
    v_add_u32 v4, 24576, v6
    s_mov_b32 s42, 1
L_p20:
    v_add_u32 v2, s43, v2
    v_add_u32 v3, s43, v3
    s_mov_b32 s43, 38912
    v_xor_b32 v4, 8192, v4
    s_barrier
    ds_read_b128 v[16:19], v2 offset:0
    ds_read_b128 v[40:43], v3 offset:0
    v_mfma_f32_16x16x32_bf16 v[32:35], v[232:235], v[20:23], v[32:35]
    ds_read_b128 v[44:47], v2 offset:2048
    v_mfma_f32_16x16x32_bf16 v[36:39], v[236:239], v[20:23], v[36:39]
    v_mfma_f32_16x16x32_bf16 v[32:35], v[240:243], v[8:11], v[32:35]
    v_mfma_f32_16x16x32_bf16 v[36:39], v[244:247], v[8:11], v[36:39]
    v_mfma_f32_16x16x32_bf16 v[32:35], v[248:251], v[12:15], v[32:35]
    v_mfma_f32_16x16x32_bf16 v[36:39], v[252:255], v[12:15], v[36:39]
    s_waitcnt lgkmcnt(1)
    v_mfma_f32_16x16x32_bf16 v[24:27], v[112:115], v[16:19], 0
    ds_read_b128 v[20:23], v3 offset:2048
    v_mfma_f32_16x16x32_bf16 v[28:31], v[116:119], v[16:19], 0
    ds_read_b128 v[8:11], v2 offset:4096
    v_mfma_f32_16x16x32_bf16 v[24:27], v[120:123], v[40:43], v[24:27]
    ds_read_b128 v[12:15], v3 offset:4096
    v_mfma_f32_16x16x32_bf16 v[28:31], v[124:127], v[40:43], v[28:31]
    ds_read_b128 v[16:19], v2 offset:6144
    v_cvt_pk_bf16_f32 v32, v32, v33
    s_waitcnt lgkmcnt(3)
    v_mfma_f32_16x16x32_bf16 v[24:27], v[128:131], v[44:47], v[24:27]
    ds_read_b128 v[40:43], v3 offset:6144
    v_mfma_f32_16x16x32_bf16 v[28:31], v[132:135], v[44:47], v[28:31]
    v_cvt_pk_bf16_f32 v33, v34, v35
    v_mfma_f32_16x16x32_bf16 v[24:27], v[136:139], v[20:23], v[24:27]
    ds_read_b128 v[44:47], v2 offset:8192
    v_mfma_f32_16x16x32_bf16 v[28:31], v[140:143], v[20:23], v[28:31]
    v_cvt_pk_bf16_f32 v34, v36, v37
    s_waitcnt lgkmcnt(3)
    v_mfma_f32_16x16x32_bf16 v[24:27], v[144:147], v[8:11], v[24:27]
    ds_read_b128 v[20:23], v3 offset:8192
    v_mfma_f32_16x16x32_bf16 v[28:31], v[148:151], v[8:11], v[28:31]
    v_cvt_pk_bf16_f32 v35, v38, v39
    v_mfma_f32_16x16x32_bf16 v[24:27], v[152:155], v[12:15], v[24:27]
    ds_read_b128 v[8:11], v2 offset:10240
    v_mfma_f32_16x16x32_bf16 v[28:31], v[156:159], v[12:15], v[28:31]
    ds_write_b128 v4, v[32:35] offset:0
    s_waitcnt lgkmcnt(4)
    v_mfma_f32_16x16x32_bf16 v[24:27], v[160:163], v[16:19], v[24:27]
    ds_read_b128 v[12:15], v3 offset:10240
    v_mfma_f32_16x16x32_bf16 v[28:31], v[164:167], v[16:19], v[28:31]
    v_mfma_f32_16x16x32_bf16 v[24:27], v[168:171], v[40:43], v[24:27]
    ds_read_b128 v[16:19], v2 offset:12288
    v_mfma_f32_16x16x32_bf16 v[28:31], v[172:175], v[40:43], v[28:31]
    s_waitcnt lgkmcnt(4)
    v_mfma_f32_16x16x32_bf16 v[24:27], v[176:179], v[44:47], v[24:27]
    ds_read_b128 v[40:43], v3 offset:12288
    v_mfma_f32_16x16x32_bf16 v[28:31], v[180:183], v[44:47], v[28:31]
    v_mfma_f32_16x16x32_bf16 v[24:27], v[184:187], v[20:23], v[24:27]
    ds_read_b128 v[44:47], v2 offset:14336
    v_mfma_f32_16x16x32_bf16 v[28:31], v[188:191], v[20:23], v[28:31]
    s_waitcnt lgkmcnt(3)
    v_mfma_f32_16x16x32_bf16 v[24:27], v[192:195], v[8:11], v[24:27]
    ds_read_b128 v[20:23], v3 offset:14336
    v_mfma_f32_16x16x32_bf16 v[28:31], v[196:199], v[8:11], v[28:31]
    v_mfma_f32_16x16x32_bf16 v[24:27], v[200:203], v[12:15], v[24:27]
    ds_read_b128 v[8:11], v2 offset:16384
    v_mfma_f32_16x16x32_bf16 v[28:31], v[204:207], v[12:15], v[28:31]
    s_waitcnt lgkmcnt(3)
    v_mfma_f32_16x16x32_bf16 v[24:27], v[208:211], v[16:19], v[24:27]
    ds_read_b128 v[12:15], v3 offset:16384
    v_mfma_f32_16x16x32_bf16 v[28:31], v[212:215], v[16:19], v[28:31]
    v_mfma_f32_16x16x32_bf16 v[24:27], v[216:219], v[40:43], v[24:27]
    ds_read_b128 v[16:19], v2 offset:18432
    v_mfma_f32_16x16x32_bf16 v[28:31], v[220:223], v[40:43], v[28:31]
    s_waitcnt lgkmcnt(3)
    v_mfma_f32_16x16x32_bf16 v[24:27], v[224:227], v[44:47], v[24:27]
    ds_read_b128 v[40:43], v3 offset:18432
    v_mfma_f32_16x16x32_bf16 v[28:31], v[228:231], v[44:47], v[28:31]
    v_mfma_f32_16x16x32_bf16 v[24:27], v[232:235], v[20:23], v[24:27]
    ds_read_b128 v[44:47], v2 offset:20480
    v_mfma_f32_16x16x32_bf16 v[28:31], v[236:239], v[20:23], v[28:31]
    s_waitcnt lgkmcnt(3)
    v_mfma_f32_16x16x32_bf16 v[24:27], v[240:243], v[8:11], v[24:27]
    ds_read_b128 v[20:23], v3 offset:20480
    v_mfma_f32_16x16x32_bf16 v[28:31], v[244:247], v[8:11], v[28:31]
    v_mfma_f32_16x16x32_bf16 v[24:27], v[248:251], v[12:15], v[24:27]
    ds_read_b128 v[8:11], v2 offset:22528
    v_mfma_f32_16x16x32_bf16 v[28:31], v[252:255], v[12:15], v[28:31]
    s_waitcnt lgkmcnt(3)
    v_mfma_f32_16x16x32_bf16 v[32:35], v[112:115], v[16:19], 0
    ds_read_b128 v[12:15], v3 offset:22528
    v_mfma_f32_16x16x32_bf16 v[36:39], v[116:119], v[16:19], 0
    v_mfma_f32_16x16x32_bf16 v[32:35], v[120:123], v[40:43], v[32:35]
    ds_read_b128 v[16:19], v2 offset:24576
    v_mfma_f32_16x16x32_bf16 v[36:39], v[124:127], v[40:43], v[36:39]
    s_waitcnt lgkmcnt(3)
    v_mfma_f32_16x16x32_bf16 v[32:35], v[128:131], v[44:47], v[32:35]
    ds_read_b128 v[40:43], v3 offset:24576
    v_mfma_f32_16x16x32_bf16 v[36:39], v[132:135], v[44:47], v[36:39]
    v_mfma_f32_16x16x32_bf16 v[32:35], v[136:139], v[20:23], v[32:35]
    ds_read_b128 v[44:47], v2 offset:26624
    v_mfma_f32_16x16x32_bf16 v[36:39], v[140:143], v[20:23], v[36:39]
    s_waitcnt lgkmcnt(3)
    v_mfma_f32_16x16x32_bf16 v[32:35], v[144:147], v[8:11], v[32:35]
    ds_read_b128 v[20:23], v3 offset:26624
    v_mfma_f32_16x16x32_bf16 v[36:39], v[148:151], v[8:11], v[36:39]
    v_cvt_pk_bf16_f32 v24, v24, v25
    v_mfma_f32_16x16x32_bf16 v[32:35], v[152:155], v[12:15], v[32:35]
    ds_read_b128 v[8:11], v2 offset:28672
    v_mfma_f32_16x16x32_bf16 v[36:39], v[156:159], v[12:15], v[36:39]
    v_cvt_pk_bf16_f32 v25, v26, v27
    s_waitcnt lgkmcnt(3)
    v_mfma_f32_16x16x32_bf16 v[32:35], v[160:163], v[16:19], v[32:35]
    ds_read_b128 v[12:15], v3 offset:28672
    v_mfma_f32_16x16x32_bf16 v[36:39], v[164:167], v[16:19], v[36:39]
    v_cvt_pk_bf16_f32 v26, v28, v29
    v_mfma_f32_16x16x32_bf16 v[32:35], v[168:171], v[40:43], v[32:35]
    ds_read_b128 v[16:19], v2 offset:30720
    v_mfma_f32_16x16x32_bf16 v[36:39], v[172:175], v[40:43], v[36:39]
    v_cvt_pk_bf16_f32 v27, v30, v31
    s_waitcnt lgkmcnt(3)
    v_mfma_f32_16x16x32_bf16 v[32:35], v[176:179], v[44:47], v[32:35]
    ds_read_b128 v[40:43], v3 offset:30720
    v_mfma_f32_16x16x32_bf16 v[36:39], v[180:183], v[44:47], v[36:39]
    ds_write_b128 v4, v[24:27] offset:4096
    v_mfma_f32_16x16x32_bf16 v[32:35], v[184:187], v[20:23], v[32:35]
    ds_read_b128 v[44:47], v2 offset:32768
    v_mfma_f32_16x16x32_bf16 v[36:39], v[188:191], v[20:23], v[36:39]
    s_waitcnt lgkmcnt(4)
    v_mfma_f32_16x16x32_bf16 v[32:35], v[192:195], v[8:11], v[32:35]
    ds_read_b128 v[20:23], v3 offset:32768
    v_mfma_f32_16x16x32_bf16 v[36:39], v[196:199], v[8:11], v[36:39]
    v_mfma_f32_16x16x32_bf16 v[32:35], v[200:203], v[12:15], v[32:35]
    ds_read_b128 v[8:11], v2 offset:34816
    v_mfma_f32_16x16x32_bf16 v[36:39], v[204:207], v[12:15], v[36:39]
    s_cmp_lg_u32 s42, 3
    s_cbranch_scc1 L_eb13
    s_waitcnt lgkmcnt(3)
    s_barrier
L_eb13:
    s_waitcnt lgkmcnt(4)
    v_mfma_f32_16x16x32_bf16 v[32:35], v[208:211], v[16:19], v[32:35]
    ds_read_b128 v[12:15], v3 offset:34816
    v_mfma_f32_16x16x32_bf16 v[36:39], v[212:215], v[16:19], v[36:39]
    v_mfma_f32_16x16x32_bf16 v[32:35], v[216:219], v[40:43], v[32:35]
    v_mfma_f32_16x16x32_bf16 v[36:39], v[220:223], v[40:43], v[36:39]
    s_waitcnt lgkmcnt(2)
    v_mfma_f32_16x16x32_bf16 v[32:35], v[224:227], v[44:47], v[32:35]
    v_mfma_f32_16x16x32_bf16 v[36:39], v[228:231], v[44:47], v[36:39]
    s_waitcnt lgkmcnt(0)
    s_add_u32 s42, s42, 1
    s_cmp_lt_u32 s42, 4
    s_cbranch_scc1 L_p20
    v_mfma_f32_16x16x32_bf16 v[32:35], v[232:235], v[20:23], v[32:35]
    v_mfma_f32_16x16x32_bf16 v[36:39], v[236:239], v[20:23], v[36:39]
    v_mfma_f32_16x16x32_bf16 v[32:35], v[240:243], v[8:11], v[32:35]
    v_mfma_f32_16x16x32_bf16 v[36:39], v[244:247], v[8:11], v[36:39]
    v_mfma_f32_16x16x32_bf16 v[32:35], v[248:251], v[12:15], v[32:35]
    v_mfma_f32_16x16x32_bf16 v[36:39], v[252:255], v[12:15], v[36:39]
    s_mov_b32 s52, 2506752
    s_nop 6
    v_cvt_pk_bf16_f32 v32, v32, v33
    v_cvt_pk_bf16_f32 v33, v34, v35
    v_cvt_pk_bf16_f32 v34, v36, v37
    v_cvt_pk_bf16_f32 v35, v38, v39
    buffer_store_dwordx4 v[32:35], v1, s[36:39], s52 offen sc1
L_end:
    .set CPL, (L_end-standalone__weight_only_int_omniquant__prompt_kernel+8191)/8192
s_endpgm
.section .rodata,"a"
.p2align 6
.amdhsa_kernel standalone__weight_only_int_omniquant__prompt_kernel
  .amdhsa_next_free_vgpr 256
  .amdhsa_next_free_sgpr 102
  .amdhsa_accum_offset 256
  .amdhsa_group_segment_fixed_size 0
  .amdhsa_kernarg_size 64
  .amdhsa_user_sgpr_count 2
  .amdhsa_user_sgpr_kernarg_segment_ptr 1
  .amdhsa_system_sgpr_workgroup_id_x 1
.end_amdhsa_kernel
```
